```python
import torch

def _softmax(x, axis=-1):
    return torch.softmax(x, dim=axis)
def _gelu(x):
    return torch.nn.functional.gelu(x, approximate="tanh")
def _silu(x):
    return torch.nn.functional.silu(x)
def _sigmoid(x):
    return torch.sigmoid(x)
def _layernorm(x, axis=-1, eps=1e-5):
    m = x.mean(dim=axis, keepdim=True)
    v = x.var(dim=axis, keepdim=True, unbiased=False)
    return (x - m) / torch.sqrt(v + eps)
def _scatter_add(tgt, idx, src, axis=0):
    return tgt.clone().index_add_(axis, idx, src)
def _segment_sum(src, seg, n):
    out = torch.zeros((n,) + src.shape[1:], dtype=src.dtype)
    return out.index_add_(0, seg, src)
def _pad(x, pw):
    flat = tuple(v for pair in reversed(pw) for v in pair)
    return torch.nn.functional.pad(x, flat)

kernel_name = 'sequential_preLN__grouped_kv_mqa__moe_arch_mod__prompt'

def setup_inputs():

    _w = (lambda a: (lambda t: t.to(torch.bfloat16) if t.is_floating_point() else t)(torch.as_tensor(a)))
    def _A_setup():
        B, S, D, H = 1, 2048, 1024, 32
        Dh = D // H
        return {
            "x": _w((lambda *s: torch.randn(*s, dtype=torch.bfloat16) * 0.05)(B, S, D)),
            "wq": _w((lambda *s: torch.randn(*s, dtype=torch.bfloat16) * 0.05)(D, H * Dh)),
            "wk": _w((lambda *s: torch.randn(*s, dtype=torch.bfloat16) * 0.05)(D, Dh)),
            "wv": _w((lambda *s: torch.randn(*s, dtype=torch.bfloat16) * 0.05)(D, Dh)),
            "wo": _w((lambda *s: torch.randn(*s, dtype=torch.bfloat16) * 0.05)(H * Dh, D)),
        }
    _A_in = _A_setup()

    def _B_setup():
        B, S, D, F, C = 1, 2048, 1024, 3584, 1
        return {
            "x": _w((lambda *s: torch.randn(*s, dtype=torch.bfloat16) * 0.05)(B, S, D)),
            "w_r": _w((lambda *s: torch.randn(*s, dtype=torch.bfloat16) * 0.05)(D)),
            "w_gate": _w((lambda *s: torch.randn(*s, dtype=torch.bfloat16) * 0.05)(D, F)),
            "w_up": _w((lambda *s: torch.randn(*s, dtype=torch.bfloat16) * 0.05)(D, F)),
            "w_down": _w((lambda *s: torch.randn(*s, dtype=torch.bfloat16) * 0.05)(F, D)),
        }
    _B_in = _B_setup()

    return {
        "A_x": _A_in["x"],
        "A_wq": _A_in["wq"],
        "A_wk": _A_in["wk"],
        "A_wv": _A_in["wv"],
        "A_wo": _A_in["wo"],
        "B_x": _B_in["x"],
        "B_w_r": _B_in["w_r"],
        "B_w_gate": _B_in["w_gate"],
        "B_w_up": _B_in["w_up"],
        "B_w_down": _B_in["w_down"],
    }

def reference(A_x, A_wq, A_wk, A_wv, A_wo, B_x, B_w_r, B_w_gate, B_w_up, B_w_down):
    def _A_ref(x, wq, wk, wv, wo):
        B, S, D = x.shape
        H = 32
        Dh = D // H
        q = (lambda x, *d: x.permute(*d))((x @ wq).reshape(B, S, H, Dh), 0, 2, 1, 3)
        k = x @ wk
        v = x @ wv
        scores = torch.einsum("bhqd,bkd->bhqk", q, k) * (Dh ** -0.5)
        p = _softmax(scores, axis=-1)
        o = torch.einsum("bhqk,bkd->bhqd", p, v)
        return (lambda x, *d: x.permute(*d))(o, 0, 2, 1, 3).reshape(B, S, H * Dh) @ wo

    def _B_ref(x, w_r, w_gate, w_up, w_down):
        B, S, D = x.shape
        C = 1
        r = x @ w_r
        idx = torch.argsort(-r, axis=-1)[:, :C]
        idx_e = (lambda x, n, axis: torch.repeat_interleave(x, n, dim=axis))(idx.reshape(B, C, 1), D, axis=2)
        x_sel = (lambda x, i, axis: torch.take_along_dim(x, i, dim=axis))(x, idx_e, axis=1)
        g = _silu(x_sel @ w_gate)
        u = x_sel @ w_up
        y = (g * u) @ w_down
        r_sel = _sigmoid((lambda x, i, axis: torch.take_along_dim(x, i, dim=axis))(r, idx, axis=1))
        y = y * r_sel.reshape(B, C, 1)
        b_off = (torch.arange(B) * S).reshape(B, 1)
        flat_idx = (idx + b_off).reshape(B * C)
        zero = (x * 0.0).reshape(B * S, D)
        upd = _scatter_add(zero, flat_idx, y.reshape(B * C, D), axis=0)
        return x + upd.reshape(B, S, D)

    x = A_x
    h = x + _A_ref(_layernorm(x, axis=-1), A_wq, A_wk, A_wv, A_wo)
    h2 = h + _B_ref(_layernorm(h, axis=-1), B_w_r, B_w_gate, B_w_up, B_w_down)
    return h2
```

```asm
; @launch grid=(256,1,1) block=(512,1,1) lds=163840
.amdgcn_target "amdgcn-amd-amdhsa--gfx950"
.text
.globl sequential_preLN__grouped_kv_mqa__moe_arch_mod__prompt_kernel
.p2align 8
.type sequential_preLN__grouped_kv_mqa__moe_arch_mod__prompt_kernel,@function
sequential_preLN__grouped_kv_mqa__moe_arch_mod__prompt_kernel:
    s_load_dwordx2 s[44:45], s[0:1], 0
    s_load_dwordx2 s[52:53], s[0:1], 16
    s_load_dwordx2 s[40:41], s[0:1], 24
    s_load_dwordx2 s[48:49], s[0:1], 8
    s_load_dwordx2 s[60:61], s[0:1], 96
    s_load_dwordx2 s[80:81], s[0:1], 88
    s_cmp_ge_u32 s2, 256
    s_cbranch_scc1 L_end
    v_lshrrev_b32 v14, 6, v0
    v_and_b32 v1, 63, v0
    v_readfirstlane_b32 s3, v14
    s_lshr_b32 s28, s2, 3
    s_and_b32 s8, s2, 7
    s_lshl_b32 s6, s8, 1
    s_and_b32 s9, s28, 1
    s_add_u32 s6, s6, s9
    s_lshr_b32 s7, s28, 1
    s_mul_i32 s9, s9, 0
    s_mul_i32 s19, s8, 1
    s_add_u32 s19, s19, s9
    s_and_b32 s4, s3, 3
    s_lshr_b32 s5, s3, 2
    s_mul_i32 s20, s4, 6144
    s_lshl_b32 s10, s6, 18
    v_lshrrev_b32 v14, 4, v1
    v_and_b32 v15, 15, v1
    v_lshlrev_b32 v4, 4, v1
    s_mov_b32 s46, 0x400000
    s_mov_b32 s47, 0x20000
    s_mov_b32 s54, 0x10000
    s_mov_b32 s55, 0x20000
    s_mov_b32 s50, 0x200000
    s_mov_b32 s51, 0x20000
    s_mov_b32 s62, 0x10000000
    s_mov_b32 s63, 0x20000
    s_mov_b32 s82, 0x100
    s_mov_b32 s83, 0x20000
    s_mov_b32 s26, 0
    s_mov_b32 s29, 49152
    s_mov_b32 s23, s29
    s_mov_b32 s16, 0
    s_lshl_b32 s24, s6, 4
    s_add_u32 s24, s24, s7
    s_lshl_b32 s24, s24, 12
    s_add_u32 s24, s24, 524288
    s_add_u32 s13, s20, 49152
    s_cmp_eq_u32 s5, 1
    s_cbranch_scc1 L_loader
    v_xor_b32 v169, v14, v15
    v_lshlrev_b32 v169, 4, v169
    v_lshl_add_u32 v164, v14, 11, v169
    v_xor_b32 v165, 64, v164
    v_add_u32 v165, 7168, v165
    v_xor_b32 v166, 128, v164
    v_add_u32 v166, 14336, v166
    v_xor_b32 v167, 192, v164
    v_add_u32 v167, 21504, v167
    s_lshr_b32 s11, s7, 1
    s_lshl_b32 s11, s11, 15
    s_add_u32 s11, s11, s10
    s_lshl_b32 s12, s4, 9
    s_add_u32 s11, s11, s12
    s_mov_b32 m0, s13
    s_setprio 1
    s_lshl_b32 s15, s2, 3
    s_add_u32 s15, s15, s3
    s_cmp_eq_u32 s15, 2
    s_waitcnt lgkmcnt(0)
    s_cbranch_scc0 L_nozero
    v_mov_b32 v172, 0
    s_mov_b32 s14, 327680
    buffer_store_dword v172, v4, s[60:63], s14 offen sc1
L_nozero:
    buffer_load_dwordx4 v164, s[44:47], s11 offen offset:0 lds
    buffer_load_dwordx4 v165, s[44:47], s11 offen offset:1024 lds
    buffer_load_dwordx4 v166, s[44:47], s11 offen offset:2048 lds
    buffer_load_dwordx4 v167, s[44:47], s11 offen offset:3072 lds
    s_add_u32 m0, s13, 24576
    s_add_u32 s11, s11, 256
    buffer_load_dwordx4 v164, s[44:47], s11 offen offset:0 lds
    buffer_load_dwordx4 v165, s[44:47], s11 offen offset:1024 lds
    buffer_load_dwordx4 v166, s[44:47], s11 offen offset:2048 lds
    buffer_load_dwordx4 v167, s[44:47], s11 offen offset:3072 lds
    s_branch L_setup
L_loader:
    v_and_b32 v168, 32, v1
    v_xor_b32 v168, v168, v4
    v_mov_b32 v176, 0
    v_mov_b32 v177, 0
    v_mov_b32 v178, 0
    v_mov_b32 v179, 0
    s_lshl_b32 s12, s4, 14
    s_bitcmp1_b32 s7, 0
    s_waitcnt lgkmcnt(0)
    s_cselect_b32 s52, s40, s52
    s_cselect_b32 s53, s41, s53
    s_and_b32 s8, s19, 7
    s_lshl_b32 s8, s8, 2
    s_add_u32 s8, s8, s4
    s_lshl_b32 s8, s8, 15
    s_and_b32 s9, s6, 1
    s_lshl_b32 s9, s9, 20
    s_add_u32 s8, s8, s9
    s_lshl_b32 s9, s7, 7
    s_add_u32 s8, s8, s9
    v_lshlrev_b32 v173, 11, v15
    buffer_load_dword v173, v173, s[48:51], s8 offen
    s_and_b32 s8, s6, 1
    s_andn2_b32 s9, s7, 1
    s_add_u32 s8, s8, s9
    s_lshl_b32 s8, s8, 9
    s_add_u32 s8, s8, s12
    v_and_b32 v173, 3, v1
    v_lshlrev_b32 v173, 7, v173
    s_add_u32 s8, s8, 8192
    s_setprio 3
    buffer_load_dword v173, v173, s[52:55], s8 offen
    s_setprio 0
    s_add_u32 m0, s13, 4096
    s_nop 0
    buffer_load_dwordx4 v168, s[52:55], s12 offen offset:0 lds
    buffer_load_dwordx4 v168, s[52:55], s12 offen offset:1024 lds
    s_add_u32 s12, s12, 2048
    s_add_u32 m0, s13, 49152
    s_nop 0
    buffer_load_dwordx4 v168, s[52:55], s12 offen offset:0 lds
    buffer_load_dwordx4 v168, s[52:55], s12 offen offset:1024 lds
    buffer_load_dwordx4 v168, s[52:55], s12 offen offset:2048 lds
    buffer_load_dwordx4 v168, s[52:55], s12 offen offset:3072 lds
    s_add_u32 s12, s12, 4096
    s_add_u32 m0, s13, 53248
    s_nop 0
    buffer_load_dwordx4 v168, s[52:55], s12 offen offset:0 lds
    buffer_load_dwordx4 v168, s[52:55], s12 offen offset:1024 lds
    s_add_u32 s12, s12, 2048
    s_add_u32 m0, s13, 28672
    s_nop 0
    buffer_load_dwordx4 v168, s[52:55], s12 offen offset:0 lds
    buffer_load_dwordx4 v168, s[52:55], s12 offen offset:1024 lds
    s_add_u32 s12, s12, 2048
    s_add_u32 m0, s13, 73728
    s_nop 0
    buffer_load_dwordx4 v168, s[52:55], s12 offen offset:0 lds
    buffer_load_dwordx4 v168, s[52:55], s12 offen offset:1024 lds
    buffer_load_dwordx4 v168, s[52:55], s12 offen offset:2048 lds
    buffer_load_dwordx4 v168, s[52:55], s12 offen offset:3072 lds
    s_add_u32 s12, s12, 4096
    s_add_u32 m0, s13, 77824
    s_nop 0
    buffer_load_dwordx4 v168, s[52:55], s12 offen offset:0 lds
    buffer_load_dwordx4 v168, s[52:55], s12 offen offset:1024 lds
    s_add_u32 s12, s12, 2048
    v_lshrrev_b32 v171, 3, v1
    v_and_b32 v172, 7, v1
    v_and_b32 v12, 1, v14
    v_lshlrev_b32 v12, 2, v12
    v_xor_b32 v12, v12, v172
    v_lshlrev_b32 v12, 4, v12
    v_lshl_add_u32 v12, v171, 11, v12
    v_xor_b32 v13, 32, v12
    v_add_u32 v13, 15360, v13
    v_xor_b32 v8, v14, v172
    v_lshlrev_b32 v8, 4, v8
    v_lshl_add_u32 v8, v171, 11, v8
    v_xor_b32 v9, 64, v8
    v_add_u32 v9, 15360, v9
    v_add_u32 v10, 30720, v8
    v_add_u32 v11, 30720, v9
    s_lshl_b32 s21, s4, 16
    s_add_u32 s21, s21, s10
    s_lshl_b32 s22, s4, 15
    s_lshl_b32 s8, s7, 7
    s_add_u32 s22, s22, s8
    s_add_u32 m0, s20, 4096
    s_and_b32 s8, s19, 7
    s_lshl_b32 s18, s8, 17
    s_add_u32 s18, s18, s22
    buffer_load_dwordx4 v12, s[48:51], s18 offen offset:0 lds
    buffer_load_dwordx4 v13, s[48:51], s18 offen offset:1024 lds
    s_add_u32 m0, s20, 0
    s_lshl_b32 s17, s8, 7
    s_add_u32 s17, s17, s21
    buffer_load_dwordx4 v8, s[44:47], s17 offen offset:0 lds
    buffer_load_dwordx4 v9, s[44:47], s17 offen offset:1024 lds
    buffer_load_dwordx4 v10, s[44:47], s17 offen offset:2048 lds
    buffer_load_dwordx4 v11, s[44:47], s17 offen offset:3072 lds
    s_add_u32 m0, s20, 28672
    s_add_u32 s18, s18, 0x100000
    buffer_load_dwordx4 v12, s[48:51], s18 offen offset:0 lds
    buffer_load_dwordx4 v13, s[48:51], s18 offen offset:1024 lds
    s_waitcnt vmcnt(8)
    s_setprio 0
    s_barrier
    s_add_u32 m0, s20, 24576
    s_add_u32 s17, s17, 1024
    buffer_load_dwordx4 v8, s[44:47], s17 offen offset:0 lds
    buffer_load_dwordx4 v9, s[44:47], s17 offen offset:1024 lds
    buffer_load_dwordx4 v10, s[44:47], s17 offen offset:2048 lds
    buffer_load_dwordx4 v11, s[44:47], s17 offen offset:3072 lds
    s_lshr_b32 s10, s28, 1
    s_lshl_b32 s10, s10, 2
    s_add_u32 s10, s10, s4
    s_lshl_b32 s10, s10, 15
    s_and_b32 s11, s28, 1
    s_lshl_b32 s11, s11, 10
    s_add_u32 s10, s10, s11
    v_lshlrev_b32 v168, 11, v15
    buffer_load_dword v168, v168, s[48:51], s10 offen offset:384
    v_mov_b32 v204, 0x3f803f80
    v_mov_b32 v205, v204
    v_mov_b32 v206, v204
    v_mov_b32 v207, v204
    v_and_b32 v195, 3, v1
    v_lshlrev_b32 v195, 3, v195
    v_bfe_u32 v172, v1, 2, 2
    v_lshl_add_u32 v195, v172, 7, v195
    v_and_b32 v172, 8, v1
    v_lshl_add_u32 v195, v172, 3, v195
    v_bfe_u32 v172, v1, 4, 1
    v_mul_u32_u24 v172, 1056, v172
    v_add_u32 v195, v195, v172
    v_lshrrev_b32 v172, 5, v1
    v_mul_u32_u24 v172, 6144, v172
    v_add_u32 v195, v195, v172
    s_lshl_b32 s8, s4, 5
    v_xor_b32 v195, s8, v195
    s_and_b32 s8, s6, 1
    s_mul_i32 s8, s8, 24576
    v_add_u32 v195, s8, v195
    v_lshlrev_b32 v164, 7, v1
    v_and_b32 v164, 0x380, v164
    s_mov_b32 s14, 327680
    s_lshl_b32 s13, s7, 12
    s_add_u32 s13, s13, 393216
    s_lshl_b32 s12, s6, 8
    s_add_u32 s12, s12, s13
    s_lshl_b32 s8, s4, 6
    s_add_u32 s12, s12, s8
    v_lshlrev_b32 v196, 2, v1
    s_setprio 2
    s_barrier
    s_add_u32 m0, s20, 53248
    s_add_u32 s19, s19, 1
    s_and_b32 s8, s19, 7
    s_lshl_b32 s18, s8, 17
    s_add_u32 s18, s18, s22
    buffer_load_dwordx4 v12, s[48:51], s18 offen offset:0 lds
    buffer_load_dwordx4 v13, s[48:51], s18 offen offset:1024 lds
    s_add_u32 m0, s20, 49152
    s_lshl_b32 s17, s8, 7
    s_add_u32 s17, s17, s21
    buffer_load_dwordx4 v8, s[44:47], s17 offen offset:0 lds
    buffer_load_dwordx4 v9, s[44:47], s17 offen offset:1024 lds
    buffer_load_dwordx4 v10, s[44:47], s17 offen offset:2048 lds
    buffer_load_dwordx4 v11, s[44:47], s17 offen offset:3072 lds
    s_add_u32 m0, s20, 77824
    s_add_u32 s18, s18, 0x100000
    buffer_load_dwordx4 v12, s[48:51], s18 offen offset:0 lds
    buffer_load_dwordx4 v13, s[48:51], s18 offen offset:1024 lds
    s_add_u32 m0, s20, 73728
    s_add_u32 s17, s17, 1024
    buffer_load_dwordx4 v8, s[44:47], s17 offen offset:0 lds
    buffer_load_dwordx4 v9, s[44:47], s17 offen offset:1024 lds
    buffer_load_dwordx4 v10, s[44:47], s17 offen offset:2048 lds
    buffer_load_dwordx4 v11, s[44:47], s17 offen offset:3072 lds
    s_waitcnt vmcnt(13)
    s_barrier
    ds_read_b64_tr_b16 v[48:49], v195 offset:4096
    ds_read_b64_tr_b16 v[50:51], v195 offset:4608
    ds_read_b64_tr_b16 v[52:53], v195 offset:16384
    ds_read_b64_tr_b16 v[54:55], v195 offset:16896
    s_add_u32 m0, s20, 102400
    s_add_u32 s19, s19, 1
    s_and_b32 s8, s19, 7
    s_lshl_b32 s18, s8, 17
    s_add_u32 s18, s18, s22
    buffer_load_dwordx4 v12, s[48:51], s18 offen offset:0 lds
    buffer_load_dwordx4 v13, s[48:51], s18 offen offset:1024 lds
    s_add_u32 m0, s20, 98304
    s_lshl_b32 s17, s8, 7
    s_add_u32 s17, s17, s21
    buffer_load_dwordx4 v8, s[44:47], s17 offen offset:0 lds
    s_waitcnt lgkmcnt(0)
    v_mfma_f32_16x16x32_bf16 v[176:179], v[204:207], v[48:51], 0
    v_mfma_f32_16x16x32_bf16 v[176:179], v[204:207], v[52:55], v[176:179]
    s_nop 7
    v_cvt_pk_bf16_f32 v177, v176, v176
    v_and_b32 v177, 0xffff0000, v177
    v_sub_f32 v176, v176, v177
    v_cvt_pk_bf16_f32 v176, v177, v176
    s_mov_b64 exec, 0xffff
    buffer_store_dword v176, v196, s[60:63], s12 offen sc1
    s_mov_b64 exec, -1
    s_cmp_eq_u32 s3, 7
    s_cselect_b32 s10, 0, 0x1000
    v_mov_b32 v166, s10
    buffer_load_dword v167, v166, s[80:83], 0 offen sc1
    buffer_load_dwordx4 v9, s[44:47], s17 offen offset:1024 lds
    buffer_load_dwordx4 v10, s[44:47], s17 offen offset:2048 lds
    buffer_load_dwordx4 v11, s[44:47], s17 offen offset:3072 lds
    s_add_u32 m0, s20, 126976
    s_add_u32 s18, s18, 0x100000
    buffer_load_dwordx4 v12, s[48:51], s18 offen offset:0 lds
    buffer_load_dwordx4 v13, s[48:51], s18 offen offset:1024 lds
    s_add_u32 m0, s20, 122880
    s_add_u32 s17, s17, 1024
    buffer_load_dwordx4 v8, s[44:47], s17 offen offset:0 lds
    s_waitcnt vmcnt(24)
    s_barrier
    buffer_load_dwordx4 v9, s[44:47], s17 offen offset:1024 lds
    buffer_load_dwordx4 v10, s[44:47], s17 offen offset:2048 lds
    buffer_load_dwordx4 v11, s[44:47], s17 offen offset:3072 lds
    s_waitcnt vmcnt(20)
    s_barrier
    s_add_u32 m0, s20, 4096
    s_add_u32 s19, s19, 1
    s_and_b32 s8, s19, 7
    s_lshl_b32 s18, s8, 17
    s_add_u32 s18, s18, s22
    buffer_load_dwordx4 v12, s[48:51], s18 offen offset:0 lds
    buffer_load_dwordx4 v13, s[48:51], s18 offen offset:1024 lds
    s_add_u32 m0, s20, 0
    s_lshl_b32 s17, s8, 7
    s_add_u32 s17, s17, s21
    buffer_load_dwordx4 v8, s[44:47], s17 offen offset:0 lds
    buffer_load_dwordx4 v9, s[44:47], s17 offen offset:1024 lds
    buffer_load_dwordx4 v10, s[44:47], s17 offen offset:2048 lds
    s_waitcnt vmcnt(14)
    s_barrier
    s_cmp_eq_u32 s3, 7
    s_cbranch_scc0 L_nosig
L_gochk:
    v_readfirstlane_b32 s10, v167
    s_nop 0
    s_cmp_eq_u32 s10, 1
    s_cbranch_scc1 L_gook
    s_add_u32 s26, s26, 1
    s_cmp_ge_u32 s26, 200000
    s_cbranch_scc1 L_gook
    buffer_load_dword v167, v166, s[80:83], 0 offen sc1
    s_waitcnt vmcnt(0)
    s_branch L_gochk
L_gook:
    s_and_b32 s10, s2, 7
    s_lshl_b32 s10, s10, 7
    s_add_u32 s10, s10, 327680
    v_mov_b32 v167, 1
    s_mov_b64 exec, 1
    buffer_atomic_add v167, v166, s[60:63], s10 offen sc1
    s_mov_b64 exec, -1
L_nosig:
    buffer_load_dwordx4 v11, s[44:47], s17 offen offset:3072 lds
    s_add_u32 m0, s20, 28672
    s_add_u32 s18, s18, 0x100000
    buffer_load_dwordx4 v12, s[48:51], s18 offen offset:0 lds
    buffer_load_dwordx4 v13, s[48:51], s18 offen offset:1024 lds
    s_add_u32 m0, s20, 24576
    s_add_u32 s17, s17, 1024
    buffer_load_dwordx4 v8, s[44:47], s17 offen offset:0 lds
    buffer_load_dwordx4 v9, s[44:47], s17 offen offset:1024 lds
    s_waitcnt vmcnt(16)
    s_barrier
    buffer_load_dwordx4 v10, s[44:47], s17 offen offset:2048 lds
    buffer_load_dwordx4 v11, s[44:47], s17 offen offset:3072 lds
    s_add_u32 m0, s20, 53248
    s_add_u32 s19, s19, 1
    s_and_b32 s8, s19, 7
    s_lshl_b32 s18, s8, 17
    s_add_u32 s18, s18, s22
    buffer_load_dwordx4 v12, s[48:51], s18 offen offset:0 lds
    buffer_load_dwordx4 v13, s[48:51], s18 offen offset:1024 lds
    s_add_u32 m0, s20, 49152
    s_lshl_b32 s17, s8, 7
    s_add_u32 s17, s17, s21
    buffer_load_dwordx4 v8, s[44:47], s17 offen offset:0 lds
    buffer_load_dwordx4 v9, s[44:47], s17 offen offset:1024 lds
    s_waitcnt vmcnt(16)
    s_barrier
    buffer_load_dwordx4 v10, s[44:47], s17 offen offset:2048 lds
    buffer_load_dwordx4 v11, s[44:47], s17 offen offset:3072 lds
    s_add_u32 m0, s20, 77824
    s_add_u32 s18, s18, 0x100000
    buffer_load_dwordx4 v12, s[48:51], s18 offen offset:0 lds
    buffer_load_dwordx4 v13, s[48:51], s18 offen offset:1024 lds
    s_add_u32 m0, s20, 73728
    s_add_u32 s17, s17, 1024
    buffer_load_dwordx4 v8, s[44:47], s17 offen offset:0 lds
    s_waitcnt vmcnt(15)
    s_barrier
    buffer_load_dwordx4 v9, s[44:47], s17 offen offset:1024 lds
    buffer_load_dwordx4 v10, s[44:47], s17 offen offset:2048 lds
    buffer_load_dwordx4 v11, s[44:47], s17 offen offset:3072 lds
    s_add_u32 m0, s20, 102400
    s_add_u32 s19, s19, 1
    s_and_b32 s8, s19, 7
    s_lshl_b32 s18, s8, 17
    s_add_u32 s18, s18, s22
    buffer_load_dwordx4 v12, s[48:51], s18 offen offset:0 lds
    buffer_load_dwordx4 v13, s[48:51], s18 offen offset:1024 lds
    s_add_u32 m0, s20, 98304
    s_lshl_b32 s17, s8, 7
    s_add_u32 s17, s17, s21
    buffer_load_dwordx4 v8, s[44:47], s17 offen offset:0 lds
    s_waitcnt vmcnt(15)
    s_barrier
    buffer_load_dwordx4 v9, s[44:47], s17 offen offset:1024 lds
    buffer_load_dwordx4 v10, s[44:47], s17 offen offset:2048 lds
    buffer_load_dwordx4 v11, s[44:47], s17 offen offset:3072 lds
    s_add_u32 m0, s20, 126976
    s_add_u32 s18, s18, 0x100000
    buffer_load_dwordx4 v12, s[48:51], s18 offen offset:0 lds
    buffer_load_dwordx4 v13, s[48:51], s18 offen offset:1024 lds
    s_waitcnt vmcnt(14)
    s_barrier
    s_add_u32 m0, s20, 122880
    s_add_u32 s17, s17, 1024
    buffer_load_dwordx4 v8, s[44:47], s17 offen offset:0 lds
    buffer_load_dwordx4 v9, s[44:47], s17 offen offset:1024 lds
    buffer_load_dwordx4 v10, s[44:47], s17 offen offset:2048 lds
    buffer_load_dwordx4 v11, s[44:47], s17 offen offset:3072 lds
    s_add_u32 m0, s20, 4096
    s_add_u32 s19, s19, 1
    s_and_b32 s8, s19, 7
    s_lshl_b32 s18, s8, 17
    s_add_u32 s18, s18, s22
    buffer_load_dwordx4 v12, s[48:51], s18 offen offset:0 lds
    s_waitcnt vmcnt(13)
    s_barrier
    buffer_load_dwordx4 v13, s[48:51], s18 offen offset:1024 lds
    s_add_u32 m0, s20, 0
    s_lshl_b32 s17, s8, 7
    s_add_u32 s17, s17, s21
    buffer_load_dwordx4 v8, s[44:47], s17 offen offset:0 lds
    buffer_load_dwordx4 v9, s[44:47], s17 offen offset:1024 lds
    buffer_load_dwordx4 v10, s[44:47], s17 offen offset:2048 lds
    buffer_load_dwordx4 v11, s[44:47], s17 offen offset:3072 lds
    s_add_u32 m0, s20, 28672
    s_add_u32 s18, s18, 0x100000
    buffer_load_dwordx4 v12, s[48:51], s18 offen offset:0 lds
    s_waitcnt vmcnt(13)
    s_barrier
    buffer_load_dwordx4 v13, s[48:51], s18 offen offset:1024 lds
    s_add_u32 m0, s20, 24576
    s_add_u32 s17, s17, 1024
    buffer_load_dwordx4 v8, s[44:47], s17 offen offset:0 lds
    s_cmp_eq_u32 s3, 4
    s_cbranch_scc0 L_nosmp
    buffer_load_dword v165, v164, s[60:63], s14 offen sc1
L_nosmp:
    buffer_load_dwordx4 v9, s[44:47], s17 offen offset:1024 lds
    buffer_load_dwordx4 v10, s[44:47], s17 offen offset:2048 lds
    buffer_load_dwordx4 v11, s[44:47], s17 offen offset:3072 lds
    s_waitcnt vmcnt(12)
    s_barrier
    s_add_u32 m0, s20, 53248
    s_add_u32 s19, s19, 1
    s_and_b32 s8, s19, 7
    s_lshl_b32 s18, s8, 17
    s_add_u32 s18, s18, s22
    buffer_load_dwordx4 v12, s[48:51], s18 offen offset:0 lds
    buffer_load_dwordx4 v13, s[48:51], s18 offen offset:1024 lds
    s_add_u32 m0, s20, 49152
    s_lshl_b32 s17, s8, 7
    s_add_u32 s17, s17, s21
    buffer_load_dwordx4 v8, s[44:47], s17 offen offset:0 lds
    buffer_load_dwordx4 v9, s[44:47], s17 offen offset:1024 lds
    buffer_load_dwordx4 v10, s[44:47], s17 offen offset:2048 lds
    buffer_load_dwordx4 v11, s[44:47], s17 offen offset:3072 lds
    s_waitcnt vmcnt(12)
    s_barrier
    s_add_u32 m0, s20, 77824
    s_add_u32 s18, s18, 0x100000
    buffer_load_dwordx4 v12, s[48:51], s18 offen offset:0 lds
    buffer_load_dwordx4 v13, s[48:51], s18 offen offset:1024 lds
    s_add_u32 m0, s20, 73728
    s_add_u32 s17, s17, 1024
    buffer_load_dwordx4 v8, s[44:47], s17 offen offset:0 lds
    buffer_load_dwordx4 v9, s[44:47], s17 offen offset:1024 lds
    buffer_load_dwordx4 v10, s[44:47], s17 offen offset:2048 lds
    s_waitcnt vmcnt(11)
    s_cmp_eq_u32 s3, 4
    s_cbranch_scc0 L_s1ok
L_s1poll:
    v_cmp_ne_u32 vcc, 32, v165
    s_nop 0
    s_cbranch_vccz L_s1ok
    s_add_u32 s26, s26, 1
    s_cmp_ge_u32 s26, 200000
    s_cbranch_scc1 L_s1ok
    buffer_load_dword v165, v164, s[60:63], s14 offen sc1
    s_waitcnt vmcnt(0)
    s_branch L_s1poll
L_s1ok:
    s_barrier
    buffer_load_dwordx4 v11, s[44:47], s17 offen offset:3072 lds
    s_mov_b32 s15, m0
    s_lshl_b32 s10, s4, 10
    s_add_u32 m0, s10, 155648
    s_add_u32 s13, s13, s10
    buffer_load_dwordx4 v4, s[60:63], s13 offen sc1 lds
    s_lshl_b32 s11, s4, 8
    s_add_u32 m0, s11, 149504
    s_lshl_b32 s12, s6, 10
    s_add_u32 s12, s12, s11
    s_add_u32 s12, s12, 262144
    buffer_load_dword v196, s[60:63], s12 offen sc1 lds
    s_add_u32 m0, s10, 151552
    s_and_b32 s12, s4, 2
    s_mul_i32 s12, s12, 7168
    s_add_u32 s10, s10, s12
    s_add_u32 s10, s10, 241664
    buffer_load_dwordx4 v4, s[60:63], s10 offen sc1 lds
    s_mov_b32 m0, s15
    s_waitcnt vmcnt(9)
    s_barrier
    s_lshl_b32 s8, s4, 13
    s_add_u32 m0, s8, 98304
    s_add_u32 s9, s8, 4096
    buffer_load_dwordx4 v4, s[60:63], s8 offen sc1 lds
    buffer_load_dwordx4 v4, s[60:63], s8 offen offset:1024 sc1 lds
    buffer_load_dwordx4 v4, s[60:63], s8 offen offset:2048 sc1 lds
    buffer_load_dwordx4 v4, s[60:63], s8 offen offset:3072 sc1 lds
    s_add_u32 m0, s8, 102400
    s_nop 0
    buffer_load_dwordx4 v4, s[60:63], s9 offen offset:0 sc1 lds
    buffer_load_dwordx4 v4, s[60:63], s9 offen offset:1024 sc1 lds
    buffer_load_dwordx4 v4, s[60:63], s9 offen offset:2048 sc1 lds
    s_waitcnt vmcnt(10)
    s_barrier
    buffer_load_dwordx4 v4, s[60:63], s9 offen offset:3072 sc1 lds
    s_waitcnt vmcnt(8)
    s_barrier
    s_setprio 0
L_setup:
    s_load_dwordx2 s[56:57], s[0:1], 32
    s_load_dwordx2 s[76:77], s[0:1], 48
    s_load_dwordx2 s[68:69], s[0:1], 56
    s_load_dwordx2 s[42:43], s[0:1], 64
    s_load_dwordx2 s[72:73], s[0:1], 72
    s_load_dwordx2 s[64:65], s[0:1], 80
    s_mov_b32 s58, 0x200000
    s_mov_b32 s59, 0x20000
    s_mov_b32 s78, 0x800
    s_mov_b32 s79, 0x20000
    s_mov_b32 s66, 0x400000
    s_mov_b32 s67, 0x20000
    s_and_b32 s8, s2, 7
    s_mul_i32 s30, s8, 28
    s_add_u32 s30, s30, s28
    s_mov_b32 s71, 0x20000
    s_mov_b32 s75, 0x20000
    s_cmp_lt_u32 s28, 28
    s_cselect_b32 s70, 0x700000, 0
    s_cselect_b32 s74, 0x700000, 0
    s_cselect_b32 s14, 0, 0x80000000
    s_lshl_b32 s37, s3, 12
    s_lshl_b32 s92, s7, 7
    s_lshl_b32 s93, s4, 1
    s_add_u32 s93, s93, s5
    s_lshr_b32 s8, s3, 1
    s_mul_i32 s38, s8, 1835008
    s_lshl_b32 s9, s30, 5
    s_add_u32 s38, s38, s9
    v_lshrrev_b32 v16, 1, v1
    v_mul_u32_u24 v16, 57344, v16
    v_and_b32 v17, 16, v4
    v_add_u32 v203, v16, v17
    s_lshl_b32 s39, s30, 15
    s_lshl_b32 s9, s3, 8
    s_add_u32 s39, s39, s9
    v_and_b32 v16, 31, v1
    v_lshrrev_b32 v17, 5, v1
    v_lshlrev_b32 v219, 14, v17
    v_lshl_add_u32 v219, v16, 3, v219
    v_lshrrev_b32 v16, 3, v16
    v_mul_u32_u24 v16, 28672, v16
    v_lshl_add_u32 v16, v17, 30, v16
    v_and_b32 v5, 0x70, v4
    s_mul_i32 s8, s3, 114688
    s_lshl_b32 s9, s30, 7
    s_add_u32 s8, s8, s9
    s_add_u32 s8, s8, 2097152
    s_or_b32 s8, s8, s14
    v_add3_u32 v5, v5, v16, s8
    v_bfe_u32 v16, v1, 4, 1
    v_lshl_add_u32 v16, v16, 1, v17
    v_lshlrev_b32 v16, 5, v16
    v_and_b32 v17, 0x70, v4
    v_xor_b32 v16, v16, v17
    v_lshrrev_b32 v17, 3, v1
    v_lshl_add_u32 v236, v17, 11, v16
    v_add_u32 v237, 15360, v236
    v_add_u32 v238, 30720, v236
    v_add_u32 v239, 46080, v236
    s_lshl_b32 s90, s3, 16
    s_add_u32 s90, s90, s92
    s_lshl_b32 s8, s6, 4
    s_add_u32 s8, s8, s4
    s_lshl_b32 s8, s8, 12
    s_add_u32 s8, s8, 524544
    v_mov_b32 v245, s8
    s_lshl_b32 s8, s6, 18
    s_lshl_b32 s9, s4, 16
    s_add_u32 s8, s8, s9
    s_lshl_b32 s9, s7, 12
    s_add_u32 s8, s8, s9
    s_lshl_b32 s8, s8, 0
    s_add_u32 s8, s8, 4194304
    v_writelane_b32 v245, s8, 1
    v_lshlrev_b32 v240, 3, v14
    v_lshl_add_u32 v227, v15, 11, v240
    s_lshl_b32 s91, s6, 18
    s_lshl_b32 s9, s93, 15
    s_add_u32 s91, s91, s9
    s_add_u32 s91, s91, s92
    s_lshl_b32 s8, s93, 8
    s_add_u32 s8, s8, s24
    s_add_u32 s8, s8, 1024
    v_lshl_add_u32 v16, v15, 4, s8
    v_lshl_add_u32 v6, v14, 2, v16
    s_lshl_b32 s8, s6, 16
    s_add_u32 s8, s8, 524416
    v_lshl_add_u32 v241, v15, 12, s8
    v_mov_b32 v228, -1
    v_mov_b32 v229, -1
    v_mov_b32 v230, -1
    v_mov_b32 v231, -1
    v_and_b32 v16, 15, v1
    v_cmp_eq_u32 vcc, 0, v16
    v_mov_b32 v17, 0x3f803f80
    v_mov_b32 v232, 0
    v_cndmask_b32 v250, 0, v17, vcc
    v_cndmask_b32 v251, 0, v17, vcc
    v_cmp_eq_u32 vcc, 4, v16
    v_mov_b32 v233, 0
    v_mov_b32 v234, 0
    v_mov_b32 v235, 0
    v_cndmask_b32 v252, 0, v17, vcc
    v_cndmask_b32 v253, 0, v17, vcc
    v_mov_b32 v2, 0xdddddddd
    s_lshl_b32 s8, s5, 14
    v_add_u32 v3, s8, v4
    v_add_u32 v7, 98304, v3
    v_add_u32 v244, 65536, v3
    s_bitcmp1_b32 s3, 0
    s_waitcnt lgkmcnt(0)
    s_cselect_b32 s68, s42, s68
    s_cselect_b32 s69, s43, s69
    s_cmp_eq_u32 s5, 1
    s_cbranch_scc1 L_loader2
    v_mov_b32 v204, 0x3f803f80
    v_mov_b32 v205, v204
    v_mov_b32 v206, v204
    v_mov_b32 v207, v204
    v_and_b32 v195, 3, v1
    v_lshlrev_b32 v195, 3, v195
    v_bfe_u32 v172, v1, 2, 2
    v_lshl_add_u32 v195, v172, 7, v195
    v_and_b32 v172, 8, v1
    v_lshl_add_u32 v195, v172, 3, v195
    v_bfe_u32 v172, v1, 4, 1
    v_mul_u32_u24 v172, 1056, v172
    v_add_u32 v195, v195, v172
    v_lshrrev_b32 v172, 5, v1
    v_mul_u32_u24 v172, 6144, v172
    v_add_u32 v195, v195, v172
    v_lshl_add_u32 v164, v15, 8, v169
    v_add_u32 v164, s13, v164
    v_mfma_f32_32x32x16_bf16 v[16:31], v[232:235], v[232:235], 0
    v_mfma_f32_32x32x16_bf16 v[32:47], v[232:235], v[232:235], 0
    v_xor_b32 v165, 64, v164
    v_xor_b32 v166, 0x80, v164
    v_xor_b32 v167, 0xc0, v164
    v_lshrrev_b32 v168, 2, v15
    v_lshl_add_u32 v168, v14, 3, v168
    v_lshlrev_b32 v168, 6, v168
    v_and_b32 v169, 1, v14
    v_lshl_add_u32 v168, v169, 5, v168
    v_and_b32 v170, 3, v1
    v_lshl_add_u32 v168, v170, 3, v168
    v_add_u32 v168, s13, v168
    v_xor_b32 v169, 32, v168
    v_add_u32 v171, 24576, v169
    v_mov_b32 v184, 0
    v_lshrrev_b32 v172, 1, v15
    v_and_b32 v173, 2, v14
    v_cmp_eq_u32 vcc, v172, v173
    v_and_b32 v194, 1, v1
    v_mul_u32_u24 v194, 0xaaaa, v194
    v_add_u32 v194, 0x4444, v194
    v_cndmask_b32 v156, 0, v204, vcc
    v_cndmask_b32 v157, 0, v204, vcc
    v_cndmask_b32 v158, 0, v204, vcc
    v_cndmask_b32 v159, 0, v204, vcc
    v_xor_b32 v172, v172, v14
    v_lshlrev_b32 v172, 4, v172
    v_lshl_add_u32 v8, v15, 7, v172
    v_add_u32 v8, s20, v8
    v_xor_b32 v9, 64, v8
    v_mov_b32 v10, v195
    v_xor_b32 v11, 32, v10
    v_xor_b32 v12, 64, v10
    v_xor_b32 v13, 0x60, v10
    s_lshl_b32 s8, s6, 2
    s_lshr_b32 s9, s7, 2
    s_add_u32 s8, s8, s9
    s_and_b32 s9, s7, 1
    s_add_u32 s9, s9, s8
    s_add_u32 s9, s9, 31
    s_and_b32 s10, s9, 28
    s_and_b32 s9, s9, 31
    s_add_u32 s9, s9, s10
    s_lshr_b32 s8, s8, 5
    s_lshl_b32 s8, s8, 2
    s_add_u32 s8, s8, s9
    s_lshl_b32 s8, s8, 12
    s_bfe_u32 s9, s7, 0x10001
    v_mov_b32 v192, 0x80000000
    s_bitcmp1_b32 s7, 0
    s_cbranch_scc1 L_roleV
    s_lshl_b32 s9, s9, 8
    s_add_u32 s8, s8, s9
    s_lshl_b32 s9, s4, 9
    s_add_u32 s8, s8, s9
    v_lshl_add_u32 v191, v1, 2, s8
    v_lshrrev_b32 v187, 2, v1
    v_mov_b32 v188, v187
    s_lshl_b32 s9, s4, 3
    v_lshl_add_u32 v185, v170, 1, s9
    v_add_u32 v186, 1, v185
    s_lshl_b32 s8, s6, 10
    s_lshl_b32 s9, s7, 6
    s_add_u32 s8, s8, s9
    s_add_u32 s8, s8, 262144
    v_and_b32 v172, 0xc3, v0
    v_cmp_eq_u32 vcc, 0, v172
    v_lshl_add_u32 v172, v0, 1, s8
    s_nop 0
    v_cndmask_b32 v192, v192, v172, vcc
    s_branch L_roleD
L_roleV:
    s_lshl_b32 s9, s9, 10
    s_add_u32 s8, s8, s9
    s_add_u32 s8, s8, 2048
    v_lshl_add_u32 v191, v0, 2, s8
    v_bfe_u32 v185, v0, 2, 5
    v_mov_b32 v186, v185
    s_and_b32 s9, s4, 2
    s_lshl_b32 s9, s9, 2
    v_lshl_add_u32 v187, v170, 1, s9
    v_add_u32 v188, 1, v187
L_roleD:
    s_mov_b32 s8, 147456
    v_add_u32 v170, 24576, v168
    v_lshrrev_b32 v172, 2, v185
    v_lshl_add_u32 v172, v172, 4, v187
    v_and_b32 v173, 3, v185
    v_lshl_add_u32 v172, v172, 2, v173
    v_lshl_add_u32 v189, v172, 2, s8
    v_lshl_add_u32 v185, v185, 4, s8
    v_lshl_add_u32 v187, v187, 4, s8
    v_lshrrev_b32 v172, 2, v186
    v_lshl_add_u32 v172, v172, 4, v188
    v_and_b32 v173, 3, v186
    v_lshl_add_u32 v172, v172, 2, v173
    v_lshl_add_u32 v190, v172, 2, s8
    v_lshl_add_u32 v186, v186, 4, s8
    v_lshl_add_u32 v188, v188, 4, s8
    s_lshl_b32 s9, s4, 11
    s_add_u32 s9, s9, 151552
    v_add_u32 v174, s9, v4
    s_lshl_b32 s9, s4, 2
    s_add_u32 s9, s9, 147456
    v_add_u32 v175, s9, v4
    s_getreg_b32 s14, hwreg(HW_REG_XCC_ID, 0, 4)
    v_lshrrev_b32 v172, 3, v1
    v_cmp_eq_u32 vcc, 1, v172
    v_mov_b32 v172, s14
    v_mov_b32 v177, -1
    v_cndmask_b32 v176, -1, v172, vcc
    v_mov_b32 v178, -1
    v_mov_b32 v179, -1
    s_waitcnt vmcnt(0)
    ds_read_b128 v[48:51], v164 offset:0
    ds_read_b128 v[52:55], v165 offset:0
    ds_read_b128 v[56:59], v166 offset:0
    ds_read_b128 v[60:63], v167 offset:0
    ds_read_b128 v[64:67], v164 offset:24576
    ds_read_b128 v[68:71], v165 offset:24576
    ds_read_b128 v[72:75], v166 offset:24576
    ds_read_b128 v[76:79], v167 offset:24576
    s_cmp_eq_u32 s15, 2
    s_cbranch_scc0 L_nogo
    v_mov_b32 v173, 1
    v_lshlrev_b32 v172, 16, v1
    buffer_store_dword v173, v172, s[80:83], 0 offen sc1
L_nogo:
    s_cmp_eq_u32 s3, 1
    s_cbranch_scc0 L_noinit
    buffer_store_dwordx4 v[176:179], v4, s[60:63], s24 offen sc1
L_noinit:
    s_waitcnt lgkmcnt(0)
    v_dot2c_f32_bf16 v184, v48, v48
    v_dot2c_f32_bf16 v184, v49, v49
    v_dot2c_f32_bf16 v184, v50, v50
    v_dot2c_f32_bf16 v184, v51, v51
    v_dot2c_f32_bf16 v184, v52, v52
    v_dot2c_f32_bf16 v184, v53, v53
    v_dot2c_f32_bf16 v184, v54, v54
    v_dot2c_f32_bf16 v184, v55, v55
    v_dot2c_f32_bf16 v184, v56, v56
    v_dot2c_f32_bf16 v184, v57, v57
    v_dot2c_f32_bf16 v184, v58, v58
    v_dot2c_f32_bf16 v184, v59, v59
    v_dot2c_f32_bf16 v184, v60, v60
    v_dot2c_f32_bf16 v184, v61, v61
    v_dot2c_f32_bf16 v184, v62, v62
    v_dot2c_f32_bf16 v184, v63, v63
    v_dot2c_f32_bf16 v184, v64, v64
    v_dot2c_f32_bf16 v184, v65, v65
    v_dot2c_f32_bf16 v184, v66, v66
    v_dot2c_f32_bf16 v184, v67, v67
    v_dot2c_f32_bf16 v184, v68, v68
    v_dot2c_f32_bf16 v184, v69, v69
    v_dot2c_f32_bf16 v184, v70, v70
    v_dot2c_f32_bf16 v184, v71, v71
    v_dot2c_f32_bf16 v184, v72, v72
    v_dot2c_f32_bf16 v184, v73, v73
    v_dot2c_f32_bf16 v184, v74, v74
    v_dot2c_f32_bf16 v184, v75, v75
    v_dot2c_f32_bf16 v184, v76, v76
    v_dot2c_f32_bf16 v184, v77, v77
    v_dot2c_f32_bf16 v184, v78, v78
    v_dot2c_f32_bf16 v184, v79, v79
    v_mfma_f32_16x16x32_bf16 v[160:163], v[204:207], v[48:51], 0
    v_mfma_f32_16x16x32_bf16 v[160:163], v[204:207], v[52:55], v[160:163]
    v_mfma_f32_16x16x32_bf16 v[160:163], v[204:207], v[56:59], v[160:163]
    v_mov_b32 v193, v184
    v_mfma_f32_16x16x32_bf16 v[160:163], v[204:207], v[60:63], v[160:163]
    v_mfma_f32_16x16x32_bf16 v[160:163], v[204:207], v[64:67], v[160:163]
    v_mfma_f32_16x16x32_bf16 v[160:163], v[204:207], v[68:71], v[160:163]
    v_mfma_f32_16x16x32_bf16 v[160:163], v[204:207], v[72:75], v[160:163]
    v_mfma_f32_16x16x32_bf16 v[160:163], v[204:207], v[76:79], v[160:163]
    v_permlane32_swap_b32 v193, v184
    v_add_f32 v184, v184, v193
    v_mov_b32 v193, v184
    v_cmp_eq_u32 vcc, 3, v14
    s_nop 0
    v_permlane16_swap_b32 v193, v184
    v_add_f32 v184, v184, v193
    s_nop 0
    v_cndmask_b32 v160, v160, v184, vcc
    v_cmp_lt_u32 vcc, 1, v14
    v_mov_b32 v153, 0
    v_mov_b32 v154, 0
    v_mov_b32 v155, 0
    v_cndmask_b32 v152, 0, v160, vcc
    s_barrier
    ds_read_b64_tr_b16 v[80:81], v168 offset:4096
    ds_read_b64_tr_b16 v[82:83], v168 offset:4352
    ds_read_b64_tr_b16 v[84:85], v169 offset:4096
    ds_read_b64_tr_b16 v[86:87], v169 offset:4352
    ds_read_b64_tr_b16 v[88:89], v168 offset:49152
    ds_read_b64_tr_b16 v[90:91], v168 offset:49408
    ds_read_b64_tr_b16 v[92:93], v169 offset:49152
    ds_read_b64_tr_b16 v[94:95], v169 offset:49408
    ds_read_b64_tr_b16 v[96:97], v168 offset:51200
    ds_read_b64_tr_b16 v[98:99], v168 offset:51456
    ds_read_b64_tr_b16 v[100:101], v169 offset:51200
    ds_read_b64_tr_b16 v[102:103], v169 offset:51456
    s_waitcnt lgkmcnt(8)
    v_smfmac_f32_16x16x64_bf16 v[152:155], v[156:159], v[80:87], v194
    ds_read_b64_tr_b16 v[104:105], v168 offset:53248
    v_mfma_f32_16x16x32_bf16 v[144:147], v[80:83], v[48:51], 0
    ds_read_b64_tr_b16 v[106:107], v168 offset:53504
    ds_read_b64_tr_b16 v[108:109], v169 offset:53248
    v_mfma_f32_16x16x32_bf16 v[148:151], v[84:87], v[48:51], 0
    ds_read_b64_tr_b16 v[110:111], v169 offset:53504
    s_waitcnt lgkmcnt(8)
    v_smfmac_f32_16x16x64_bf16 v[152:155], v[156:159], v[88:95], v194
    ds_read_b64_tr_b16 v[112:113], v170 offset:4096
    v_mfma_f32_16x16x32_bf16 v[144:147], v[88:91], v[52:55], v[144:147]
    ds_read_b64_tr_b16 v[114:115], v170 offset:4352
    ds_read_b64_tr_b16 v[116:117], v171 offset:4096
    v_mfma_f32_16x16x32_bf16 v[148:151], v[92:95], v[52:55], v[148:151]
    ds_read_b64_tr_b16 v[118:119], v171 offset:4352
    s_waitcnt lgkmcnt(8)
    v_smfmac_f32_16x16x64_bf16 v[152:155], v[156:159], v[96:103], v194
    ds_read_b64_tr_b16 v[120:121], v170 offset:49152
    v_mfma_f32_16x16x32_bf16 v[144:147], v[96:99], v[56:59], v[144:147]
    ds_read_b64_tr_b16 v[122:123], v170 offset:49408
    ds_read_b64_tr_b16 v[124:125], v171 offset:49152
    v_mfma_f32_16x16x32_bf16 v[148:151], v[100:103], v[56:59], v[148:151]
    ds_read_b64_tr_b16 v[126:127], v171 offset:49408
    s_waitcnt lgkmcnt(8)
    v_smfmac_f32_16x16x64_bf16 v[152:155], v[156:159], v[104:111], v194
    ds_read_b64_tr_b16 v[128:129], v170 offset:51200
    v_mfma_f32_16x16x32_bf16 v[144:147], v[104:107], v[60:63], v[144:147]
    ds_read_b64_tr_b16 v[130:131], v170 offset:51456
    ds_read_b64_tr_b16 v[132:133], v171 offset:51200
    v_mfma_f32_16x16x32_bf16 v[148:151], v[108:111], v[60:63], v[148:151]
    ds_read_b64_tr_b16 v[134:135], v171 offset:51456
    s_waitcnt lgkmcnt(8)
    v_smfmac_f32_16x16x64_bf16 v[152:155], v[156:159], v[112:119], v194
    ds_read_b64_tr_b16 v[136:137], v170 offset:53248
    v_mfma_f32_16x16x32_bf16 v[144:147], v[112:115], v[64:67], v[144:147]
    ds_read_b64_tr_b16 v[138:139], v170 offset:53504
    ds_read_b64_tr_b16 v[140:141], v171 offset:53248
    v_mfma_f32_16x16x32_bf16 v[148:151], v[116:119], v[64:67], v[148:151]
    ds_read_b64_tr_b16 v[142:143], v171 offset:53504
    s_waitcnt lgkmcnt(4)
    v_smfmac_f32_16x16x64_bf16 v[152:155], v[156:159], v[120:127], v194
    v_mfma_f32_16x16x32_bf16 v[144:147], v[120:123], v[68:71], v[144:147]
    v_mfma_f32_16x16x32_bf16 v[148:151], v[124:127], v[68:71], v[148:151]
    s_waitcnt lgkmcnt(0)
    s_barrier
    v_smfmac_f32_16x16x64_bf16 v[152:155], v[156:159], v[128:135], v194
    v_mfma_f32_16x16x32_bf16 v[144:147], v[128:131], v[72:75], v[144:147]
    v_mfma_f32_16x16x32_bf16 v[148:151], v[132:135], v[72:75], v[148:151]
    v_smfmac_f32_16x16x64_bf16 v[152:155], v[156:159], v[136:143], v194
    v_mfma_f32_16x16x32_bf16 v[144:147], v[136:139], v[76:79], v[144:147]
    v_mfma_f32_16x16x32_bf16 v[148:151], v[140:143], v[76:79], v[148:151]
    s_nop 5
    v_add_f32 v152, v152, v153
    ds_write_b128 v174, v[144:147]
    ds_write_b128 v174, v[148:151] offset:1024
    ds_write_b32 v175, v152
    s_waitcnt lgkmcnt(0)
    s_barrier
    ds_read_b128 v[96:99], v187 offset:512
    ds_read_b128 v[100:103], v187 offset:768
    ds_read_b128 v[104:107], v185
    ds_read2st64_b32 v[108:109], v189 offset0:16 offset1:24
    ds_read2st64_b32 v[110:111], v189 offset0:32 offset1:40
    ds_read_b128 v[112:115], v188 offset:512
    ds_read_b128 v[116:119], v188 offset:768
    ds_read_b128 v[120:123], v186
    ds_read2st64_b32 v[124:125], v190 offset0:16 offset1:24
    ds_read2st64_b32 v[126:127], v190 offset0:32 offset1:40
    ds_read_b128 v[48:51], v8 offset:0
    ds_read_b128 v[52:55], v8 offset:2048
    ds_read_b64_tr_b16 v[56:57], v10 offset:4096
    ds_read_b64_tr_b16 v[58:59], v10 offset:4608
    s_waitcnt lgkmcnt(9)
    v_pk_add_f32 v[96:97], v[96:97], v[98:99]
    v_pk_add_f32 v[100:101], v[100:101], v[102:103]
    v_pk_add_f32 v[104:105], v[104:105], v[106:107]
    v_pk_add_f32 v[108:109], v[108:109], v[110:111]
    v_add_f32 v96, v96, v97
    v_add_f32 v100, v100, v101
    v_add_f32 v104, v104, v105
    v_add_f32 v108, v108, v109
    ds_read_b64_tr_b16 v[60:61], v11 offset:4096
    ds_read_b64_tr_b16 v[62:63], v11 offset:4608
    ds_read_b64_tr_b16 v[64:65], v12 offset:4096
    ds_read_b64_tr_b16 v[66:67], v12 offset:4608
    v_mul_f32 v196, 0x3a800000, v96
    v_mul_f32 v98, v196, v196
    v_sub_f32 v98, 0x3727c5ac, v98
    v_fmamk_f32 v97, v100, 0x3a800000, v98
    v_max_f32 v97, 0x3727c5ac, v97
    v_rsq_f32 v197, v97
    v_fma_f32 v98, -v196, v104, v108
    v_mul_f32 v98, v98, v197
    s_waitcnt lgkmcnt(8)
    ds_read_b64_tr_b16 v[68:69], v13 offset:4096
    ds_read_b64_tr_b16 v[70:71], v13 offset:4608
    ds_read_b128 v[72:75], v9 offset:0
    ds_read_b128 v[76:79], v9 offset:2048
    v_pk_add_f32 v[112:113], v[112:113], v[114:115]
    v_pk_add_f32 v[116:117], v[116:117], v[118:119]
    v_pk_add_f32 v[120:121], v[120:121], v[122:123]
    v_pk_add_f32 v[124:125], v[124:125], v[126:127]
    v_add_f32 v112, v112, v113
    v_add_f32 v116, v116, v117
    v_add_f32 v120, v120, v121
    v_add_f32 v124, v124, v125
    ds_read_b64_tr_b16 v[80:81], v10 offset:16384
    ds_read_b64_tr_b16 v[82:83], v10 offset:16896
    ds_read_b64_tr_b16 v[84:85], v11 offset:16384
    ds_read_b64_tr_b16 v[86:87], v11 offset:16896
    v_mul_f32 v198, 0x3a800000, v112
    v_mul_f32 v114, v198, v198
    v_sub_f32 v114, 0x3727c5ac, v114
    v_fmamk_f32 v113, v116, 0x3a800000, v114
    v_max_f32 v113, 0x3727c5ac, v113
    ds_read_b64_tr_b16 v[88:89], v12 offset:16384
    ds_read_b64_tr_b16 v[90:91], v12 offset:16896
    ds_read_b64_tr_b16 v[92:93], v13 offset:16384
    ds_read_b64_tr_b16 v[94:95], v13 offset:16896
    v_rsq_f32 v199, v113
    v_fma_f32 v114, -v198, v120, v124
    v_mul_f32 v114, v114, v199
    v_cvt_pk_bf16_f32 v200, v98, v114
    s_setprio 3
    s_waitcnt lgkmcnt(12)
    v_mfma_f32_16x16x32_bf16 v[16:19], v[56:59], v[48:51], v[16:19]
    v_mfma_f32_16x16x32_bf16 v[32:35], v[56:59], v[52:55], v[32:35]
    buffer_store_dword v200, v191, s[60:63], 0 offen sc1
    v_mfma_f32_16x16x32_bf16 v[20:23], v[60:63], v[48:51], v[20:23]
    v_mfma_f32_16x16x32_bf16 v[36:39], v[60:63], v[52:55], v[36:39]
    buffer_store_dwordx2 v[196:197], v192, s[60:63], 0 offen sc1
    s_setprio 0
    v_mfma_f32_16x16x32_bf16 v[24:27], v[64:67], v[48:51], v[24:27]
    v_mfma_f32_16x16x32_bf16 v[40:43], v[64:67], v[52:55], v[40:43]
    v_lshlrev_b32 v14, 10, v14
    v_lshl_add_u32 v14, v15, 2, v14
    v_add_u32 v14, 155648, v14
    s_lshl_b32 s8, s4, 8
    s_add_u32 s8, s8, 149504
    v_lshl_add_u32 v246, v15, 3, s8
    s_lshl_b32 s8, s4, 12
    v_add_u32 v15, s8, v4
L_cmid:
    s_barrier
    s_waitcnt lgkmcnt(10)
    v_mfma_f32_16x16x32_bf16 v[28:31], v[68:71], v[48:51], v[28:31]
    ds_read_b128 v[96:99], v8 offset:24576
    ds_read_b128 v[100:103], v8 offset:26624
    v_mfma_f32_16x16x32_bf16 v[44:47], v[68:71], v[52:55], v[44:47]
    ds_read_b64_tr_b16 v[104:105], v10 offset:28672
    s_waitcnt lgkmcnt(9)
    v_mfma_f32_16x16x32_bf16 v[16:19], v[80:83], v[72:75], v[16:19]
    ds_read_b64_tr_b16 v[106:107], v10 offset:29184
    ds_read_b64_tr_b16 v[108:109], v11 offset:28672
    v_mfma_f32_16x16x32_bf16 v[32:35], v[80:83], v[76:79], v[32:35]
    ds_read_b64_tr_b16 v[110:111], v11 offset:29184
    s_waitcnt lgkmcnt(10)
    v_mfma_f32_16x16x32_bf16 v[20:23], v[84:87], v[72:75], v[20:23]
    ds_read_b64_tr_b16 v[112:113], v12 offset:28672
    ds_read_b64_tr_b16 v[114:115], v12 offset:29184
    v_mfma_f32_16x16x32_bf16 v[36:39], v[84:87], v[76:79], v[36:39]
    ds_read_b64_tr_b16 v[116:117], v13 offset:28672
    s_waitcnt lgkmcnt(11)
    v_mfma_f32_16x16x32_bf16 v[24:27], v[88:91], v[72:75], v[24:27]
    ds_read_b64_tr_b16 v[118:119], v13 offset:29184
    ds_read_b128 v[120:123], v9 offset:24576
    v_mfma_f32_16x16x32_bf16 v[40:43], v[88:91], v[76:79], v[40:43]
    ds_read_b128 v[124:127], v9 offset:26624
    s_waitcnt lgkmcnt(12)
    v_mfma_f32_16x16x32_bf16 v[28:31], v[92:95], v[72:75], v[28:31]
    ds_read_b64_tr_b16 v[128:129], v10 offset:40960
    ds_read_b64_tr_b16 v[130:131], v10 offset:41472
    v_mfma_f32_16x16x32_bf16 v[44:47], v[92:95], v[76:79], v[44:47]
    ds_read_b64_tr_b16 v[132:133], v11 offset:40960
    s_waitcnt lgkmcnt(11)
    v_mfma_f32_16x16x32_bf16 v[16:19], v[104:107], v[96:99], v[16:19]
    ds_read_b64_tr_b16 v[134:135], v11 offset:41472
    ds_read_b64_tr_b16 v[136:137], v12 offset:40960
    v_mfma_f32_16x16x32_bf16 v[32:35], v[104:107], v[100:103], v[32:35]
    ds_read_b64_tr_b16 v[138:139], v12 offset:41472
    s_waitcnt lgkmcnt(12)
    v_mfma_f32_16x16x32_bf16 v[20:23], v[108:111], v[96:99], v[20:23]
    ds_read_b64_tr_b16 v[140:141], v13 offset:40960
    ds_read_b64_tr_b16 v[142:143], v13 offset:41472
    v_mfma_f32_16x16x32_bf16 v[36:39], v[108:111], v[100:103], v[36:39]
    v_add_u32 v8, s23, v8
    v_add_u32 v9, s23, v9
    s_waitcnt lgkmcnt(12)
    v_mfma_f32_16x16x32_bf16 v[24:27], v[112:115], v[96:99], v[24:27]
    v_add_u32 v10, s23, v10
    v_add_u32 v11, s23, v11
    v_mfma_f32_16x16x32_bf16 v[40:43], v[112:115], v[100:103], v[40:43]
    v_add_u32 v12, s23, v12
    v_add_u32 v13, s23, v13
    s_barrier
    s_waitcnt lgkmcnt(10)
    v_mfma_f32_16x16x32_bf16 v[28:31], v[116:119], v[96:99], v[28:31]
    ds_read_b128 v[48:51], v8 offset:0
    ds_read_b128 v[52:55], v8 offset:2048
    v_mfma_f32_16x16x32_bf16 v[44:47], v[116:119], v[100:103], v[44:47]
    ds_read_b64_tr_b16 v[56:57], v10 offset:4096
    s_waitcnt lgkmcnt(9)
    v_mfma_f32_16x16x32_bf16 v[16:19], v[128:131], v[120:123], v[16:19]
    ds_read_b64_tr_b16 v[58:59], v10 offset:4608
    ds_read_b64_tr_b16 v[60:61], v11 offset:4096
    v_mfma_f32_16x16x32_bf16 v[32:35], v[128:131], v[124:127], v[32:35]
    ds_read_b64_tr_b16 v[62:63], v11 offset:4608
    s_waitcnt lgkmcnt(10)
    v_mfma_f32_16x16x32_bf16 v[20:23], v[132:135], v[120:123], v[20:23]
    ds_read_b64_tr_b16 v[64:65], v12 offset:4096
    ds_read_b64_tr_b16 v[66:67], v12 offset:4608
    v_mfma_f32_16x16x32_bf16 v[36:39], v[132:135], v[124:127], v[36:39]
    ds_read_b64_tr_b16 v[68:69], v13 offset:4096
    s_waitcnt lgkmcnt(11)
    v_mfma_f32_16x16x32_bf16 v[24:27], v[136:139], v[120:123], v[24:27]
    ds_read_b64_tr_b16 v[70:71], v13 offset:4608
    ds_read_b128 v[72:75], v9 offset:0
    v_mfma_f32_16x16x32_bf16 v[40:43], v[136:139], v[124:127], v[40:43]
    ds_read_b128 v[76:79], v9 offset:2048
    s_waitcnt lgkmcnt(12)
    v_mfma_f32_16x16x32_bf16 v[28:31], v[140:143], v[120:123], v[28:31]
    ds_read_b64_tr_b16 v[80:81], v10 offset:16384
    ds_read_b64_tr_b16 v[82:83], v10 offset:16896
    v_mfma_f32_16x16x32_bf16 v[44:47], v[140:143], v[124:127], v[44:47]
    ds_read_b64_tr_b16 v[84:85], v11 offset:16384
    s_waitcnt lgkmcnt(11)
    v_mfma_f32_16x16x32_bf16 v[16:19], v[56:59], v[48:51], v[16:19]
    ds_read_b64_tr_b16 v[86:87], v11 offset:16896
    ds_read_b64_tr_b16 v[88:89], v12 offset:16384
    v_mfma_f32_16x16x32_bf16 v[32:35], v[56:59], v[52:55], v[32:35]
    ds_read_b64_tr_b16 v[90:91], v12 offset:16896
    s_waitcnt lgkmcnt(12)
    v_mfma_f32_16x16x32_bf16 v[20:23], v[60:63], v[48:51], v[20:23]
    ds_read_b64_tr_b16 v[92:93], v13 offset:16384
    ds_read_b64_tr_b16 v[94:95], v13 offset:16896
    v_mfma_f32_16x16x32_bf16 v[36:39], v[60:63], v[52:55], v[36:39]
    s_add_u32 s16, s16, 1
    s_lshl_b32 s8, 1, s16
    s_and_b32 s8, s8, 0x24
    s_cselect_b32 s23, 0xfffe8000, s29
    s_waitcnt lgkmcnt(12)
    v_mfma_f32_16x16x32_bf16 v[24:27], v[64:67], v[48:51], v[24:27]
    s_cmp_lt_u32 s16, 7
    s_waitcnt vmcnt(0)
    v_mfma_f32_16x16x32_bf16 v[40:43], v[64:67], v[52:55], v[40:43]
    s_cbranch_scc1 L_cmid
L_code0:
    s_barrier
    s_waitcnt lgkmcnt(10)
    v_mfma_f32_16x16x32_bf16 v[28:31], v[68:71], v[48:51], v[28:31]
    ds_read_b128 v[96:99], v8 offset:24576
    ds_read_b128 v[100:103], v8 offset:26624
    v_mfma_f32_16x16x32_bf16 v[44:47], v[68:71], v[52:55], v[44:47]
    ds_read_b64_tr_b16 v[104:105], v10 offset:28672
    ds_read_b64_tr_b16 v[106:107], v10 offset:29184
    s_waitcnt lgkmcnt(10)
    v_mfma_f32_16x16x32_bf16 v[16:19], v[80:83], v[72:75], v[16:19]
    ds_read_b64_tr_b16 v[108:109], v11 offset:28672
    ds_read_b64_tr_b16 v[110:111], v11 offset:29184
    v_mfma_f32_16x16x32_bf16 v[32:35], v[80:83], v[76:79], v[32:35]
    ds_read_b128 v[172:175], v9 offset:24576
    ds_read_b128 v[176:179], v9 offset:26624
    s_waitcnt lgkmcnt(12)
    v_mfma_f32_16x16x32_bf16 v[20:23], v[84:87], v[72:75], v[20:23]
    ds_read_b64_tr_b16 v[180:181], v10 offset:40960
    ds_read_b64_tr_b16 v[182:183], v10 offset:41472
    v_mfma_f32_16x16x32_bf16 v[36:39], v[84:87], v[76:79], v[36:39]
    ds_read_b64_tr_b16 v[184:185], v11 offset:40960
    ds_read_b64_tr_b16 v[186:187], v11 offset:41472
    s_waitcnt lgkmcnt(14)
    v_mfma_f32_16x16x32_bf16 v[24:27], v[88:91], v[72:75], v[24:27]
    ds_read_b64_tr_b16 v[112:113], v12 offset:28672
    ds_read_b64_tr_b16 v[114:115], v12 offset:29184
    v_mfma_f32_16x16x32_bf16 v[40:43], v[88:91], v[76:79], v[40:43]
    ds_read_b64_tr_b16 v[116:117], v13 offset:28672
    ds_read_b64_tr_b16 v[118:119], v13 offset:29184
    s_waitcnt lgkmcnt(14)
    v_mfma_f32_16x16x32_bf16 v[28:31], v[92:95], v[72:75], v[28:31]
    ds_read_b64_tr_b16 v[188:189], v12 offset:40960
    ds_read_b64_tr_b16 v[190:191], v12 offset:41472
    v_mfma_f32_16x16x32_bf16 v[44:47], v[92:95], v[76:79], v[44:47]
    ds_read_b64_tr_b16 v[192:193], v13 offset:40960
    ds_read_b64_tr_b16 v[194:195], v13 offset:41472
    s_waitcnt lgkmcnt(14)
    v_mfma_f32_16x16x32_bf16 v[16:19], v[104:107], v[96:99], v[16:19]
    s_barrier
    ds_read2_b32 v[48:49], v14 offset0:0 offset1:64
    ds_read2_b32 v[50:51], v14 offset0:128 offset1:192
    v_mfma_f32_16x16x32_bf16 v[32:35], v[104:107], v[100:103], v[32:35]
    ds_read2_b64 v[246:249], v246 offset0:0 offset1:16
    ds_read2_b32 v[52:53], v14 offset0:16 offset1:80
    v_mfma_f32_16x16x32_bf16 v[20:23], v[108:111], v[96:99], v[20:23]
    ds_read2_b32 v[54:55], v14 offset0:144 offset1:208
    ds_read2_b32 v[56:57], v14 offset0:32 offset1:96
    v_mfma_f32_16x16x32_bf16 v[36:39], v[108:111], v[100:103], v[36:39]
    ds_read2_b32 v[58:59], v14 offset0:160 offset1:224
    ds_read2_b32 v[60:61], v14 offset0:48 offset1:112
    s_waitcnt lgkmcnt(14)
    v_mfma_f32_16x16x32_bf16 v[16:19], v[180:183], v[172:175], v[16:19]
    ds_read2_b32 v[62:63], v14 offset0:176 offset1:240
    ds_read_b128 v[148:151], v7 offset:53248
    s_waitcnt lgkmcnt(8)
    v_mfma_f32_16x16x32_bf16 v[156:159], v[48:51], v[204:207], 0
    v_mfma_f32_16x16x32_bf16 v[32:35], v[180:183], v[176:179], v[32:35]
    ds_read_b128 v[152:155], v7 offset:54272
    s_waitcnt lgkmcnt(6)
    v_mfma_f32_16x16x32_bf16 v[160:163], v[52:55], v[204:207], 0
    v_mul_f32 v247, 0x3e8293ee, v247
    v_mul_f32 v249, 0x3e8293ee, v249
    v_mfma_f32_16x16x32_bf16 v[20:23], v[184:187], v[172:175], v[20:23]
    s_waitcnt lgkmcnt(4)
    v_mfma_f32_16x16x32_bf16 v[164:167], v[56:59], v[204:207], 0
    v_mul_f32 v246, v246, v247
    v_mul_f32 v248, v248, v249
    v_mfma_f32_16x16x32_bf16 v[36:39], v[184:187], v[176:179], v[36:39]
    s_waitcnt lgkmcnt(2)
    v_mfma_f32_16x16x32_bf16 v[168:171], v[60:63], v[204:207], 0
    v_mul_f32 v196, v246, v156
    v_mul_f32 v197, v246, v157
    v_mul_f32 v198, v246, v158
    v_mfma_f32_16x16x32_bf16 v[24:27], v[112:115], v[96:99], v[24:27]
    v_mul_f32 v199, v246, v159
    v_mul_f32 v156, v248, v156
    v_mul_f32 v157, v248, v157
    v_mfma_f32_16x16x32_bf16 v[40:43], v[112:115], v[100:103], v[40:43]
    v_mul_f32 v158, v248, v158
    v_mul_f32 v159, v248, v159
    v_fma_f32 v16, v16, v247, -v196
    v_mfma_f32_16x16x32_bf16 v[28:31], v[116:119], v[96:99], v[28:31]
    v_fma_f32 v17, v17, v247, -v197
    v_fma_f32 v18, v18, v247, -v198
    v_fma_f32 v19, v19, v247, -v199
    v_mfma_f32_16x16x32_bf16 v[44:47], v[116:119], v[100:103], v[44:47]
    v_fma_f32 v32, v32, v249, -v156
    v_fma_f32 v33, v33, v249, -v157
    v_fma_f32 v34, v34, v249, -v158
    v_mfma_f32_16x16x32_bf16 v[24:27], v[188:191], v[172:175], v[24:27]
    v_fma_f32 v35, v35, v249, -v159
    v_cvt_pk_bf16_f32 v132, v16, v17
    v_cvt_pk_bf16_f32 v133, v18, v19
    v_mfma_f32_16x16x32_bf16 v[40:43], v[188:191], v[176:179], v[40:43]
    v_cvt_pk_bf16_f32 v134, v32, v33
    v_cvt_pk_bf16_f32 v135, v34, v35
    v_mul_f32 v144, v246, v160
    v_mfma_f32_16x16x32_bf16 v[28:31], v[192:195], v[172:175], v[28:31]
    v_mul_f32 v145, v246, v161
    v_mul_f32 v146, v246, v162
    v_mul_f32 v147, v246, v163
    v_mfma_f32_16x16x32_bf16 v[44:47], v[192:195], v[176:179], v[44:47]
    v_permlane16_swap_b32 v132, v134
    v_permlane16_swap_b32 v133, v135
    ds_write_b128 v15, v[132:135] offset:32768
    v_mul_f32 v160, v248, v160
    v_mul_f32 v161, v248, v161
    v_mul_f32 v162, v248, v162
    v_mul_f32 v163, v248, v163
    v_fma_f32 v20, v20, v247, -v144
    v_fma_f32 v21, v21, v247, -v145
    v_fma_f32 v22, v22, v247, -v146
    v_fma_f32 v23, v23, v247, -v147
    v_fma_f32 v36, v36, v249, -v160
    v_fma_f32 v37, v37, v249, -v161
    v_fma_f32 v38, v38, v249, -v162
    v_fma_f32 v39, v39, v249, -v163
    v_cvt_pk_bf16_f32 v136, v20, v21
    v_cvt_pk_bf16_f32 v137, v22, v23
    v_cvt_pk_bf16_f32 v138, v36, v37
    v_cvt_pk_bf16_f32 v139, v38, v39
    v_mul_f32 v196, v246, v164
    v_mul_f32 v197, v246, v165
    v_mul_f32 v198, v246, v166
    v_mul_f32 v199, v246, v167
    v_permlane16_swap_b32 v136, v138
    v_permlane16_swap_b32 v137, v139
    ds_write_b128 v15, v[136:139] offset:33792
    v_mul_f32 v164, v248, v164
    v_mul_f32 v165, v248, v165
    v_mul_f32 v166, v248, v166
    v_mul_f32 v167, v248, v167
    v_fma_f32 v24, v24, v247, -v196
    v_fma_f32 v25, v25, v247, -v197
    v_fma_f32 v26, v26, v247, -v198
    v_fma_f32 v27, v27, v247, -v199
    v_fma_f32 v40, v40, v249, -v164
    v_fma_f32 v41, v41, v249, -v165
    v_fma_f32 v42, v42, v249, -v166
    v_fma_f32 v43, v43, v249, -v167
    v_cvt_pk_bf16_f32 v124, v24, v25
    v_cvt_pk_bf16_f32 v125, v26, v27
    v_cvt_pk_bf16_f32 v126, v40, v41
    v_cvt_pk_bf16_f32 v127, v42, v43
    v_mul_f32 v144, v246, v168
    v_mul_f32 v145, v246, v169
    v_mul_f32 v146, v246, v170
    v_mul_f32 v147, v246, v171
    v_permlane16_swap_b32 v124, v126
    v_permlane16_swap_b32 v125, v127
    ds_write_b128 v15, v[124:127] offset:34816
    v_mul_f32 v168, v248, v168
    v_mul_f32 v169, v248, v169
    v_mul_f32 v170, v248, v170
    v_mul_f32 v171, v248, v171
    v_fma_f32 v28, v28, v247, -v144
    v_fma_f32 v29, v29, v247, -v145
    v_fma_f32 v30, v30, v247, -v146
    v_fma_f32 v31, v31, v247, -v147
    v_fma_f32 v44, v44, v249, -v168
    v_fma_f32 v45, v45, v249, -v169
    v_fma_f32 v46, v46, v249, -v170
    v_fma_f32 v47, v47, v249, -v171
    v_cvt_pk_bf16_f32 v128, v28, v29
    v_cvt_pk_bf16_f32 v129, v30, v31
    v_cvt_pk_bf16_f32 v130, v44, v45
    v_cvt_pk_bf16_f32 v131, v46, v47
    s_nop 0
    v_permlane16_swap_b32 v128, v130
    v_permlane16_swap_b32 v129, v131
    ds_write_b128 v15, v[128:131] offset:35840
    s_waitcnt lgkmcnt(4)
    v_mfma_f32_32x32x16_bf16 v[16:31], v[148:151], v[124:127], 0
    v_mfma_f32_32x32x16_bf16 v[16:31], v[152:155], v[128:131], v[16:31]
    s_setprio 3
    s_waitcnt lgkmcnt(0)
    s_barrier
    s_branch L_qfin
L_loader2:
    ds_read_b128 v[148:151], v7 offset:38912
    ds_read_b128 v[152:155], v7 offset:39936
    s_lshl_b32 s8, s4, 12
    v_add_u32 v14, s8, v4
    s_waitcnt vmcnt(0) lgkmcnt(0)
    s_barrier
    ds_read_b128 v[124:127], v14 offset:32768
    ds_read_b128 v[128:131], v14 offset:33792
    ds_read_b128 v[132:135], v14 offset:34816
    ds_read_b128 v[136:139], v14 offset:35840
    s_waitcnt lgkmcnt(2)
    v_mfma_f32_32x32x16_bf16 v[16:31], v[148:151], v[124:127], 0
    v_mfma_f32_32x32x16_bf16 v[16:31], v[152:155], v[128:131], v[16:31]
    s_setprio 3
    s_waitcnt lgkmcnt(0)
L_qfin:
    v_mfma_f32_32x32x16_bf16 v[32:47], v[148:151], v[132:135], 0
    ds_read_b128 v[140:143], v7 offset:0
    ds_read_b128 v[144:147], v7 offset:1024
    s_nop 6
    v_exp_f32 v48, v16
    v_exp_f32 v49, v17
    v_exp_f32 v50, v18
    v_mfma_f32_32x32x16_bf16 v[32:47], v[152:155], v[136:139], v[32:47]
    ds_read_b128 v[156:159], v7 offset:2048
    ds_read_b128 v[160:163], v7 offset:3072
    v_exp_f32 v51, v19
    v_exp_f32 v52, v20
    v_exp_f32 v53, v21
    v_exp_f32 v54, v22
    v_mfma_f32_32x32x16_bf16 v[80:95], v[232:235], v[232:235], 0
    v_exp_f32 v55, v23
    v_exp_f32 v56, v24
    v_exp_f32 v57, v25
    v_mfma_f32_32x32x16_bf16 v[96:111], v[232:235], v[232:235], 0
    s_add_u32 m0, s37, 131072
    s_add_u32 s12, s37, 32768
    buffer_load_dwordx4 v4, s[60:63], s12 offen offset:0 sc1 lds
    v_exp_f32 v58, v26
    v_exp_f32 v59, v27
    v_exp_f32 v60, v28
    v_mfma_f32_16x16x32_bf16 v[112:115], v[232:235], v[232:235], 0
    v_exp_f32 v61, v29
    v_mfma_f32_16x16x32_bf16 v[116:119], v[232:235], v[232:235], 0
    buffer_load_dwordx4 v4, s[60:63], s12 offen offset:1024 sc1 lds
    v_exp_f32 v62, v30
    v_exp_f32 v63, v31
    s_waitcnt lgkmcnt(0)
    v_mfma_f32_32x32x16_bf16 v[16:31], v[140:143], v[124:127], 0
    v_exp_f32 v64, v32
    v_exp_f32 v65, v33
    v_exp_f32 v66, v34
    v_mfma_f32_32x32x16_bf16 v[16:31], v[144:147], v[128:131], v[16:31]
    v_exp_f32 v67, v35
    v_exp_f32 v68, v36
    v_exp_f32 v69, v37
    v_exp_f32 v70, v38
    v_smfmac_f32_32x32x32_bf16 v[80:95], v[156:159], v[48:55], v2
    v_exp_f32 v71, v39
    v_exp_f32 v72, v40
    v_exp_f32 v73, v41
    v_smfmac_f32_32x32x32_bf16 v[80:95], v[160:163], v[56:63], v2
    buffer_load_dwordx4 v4, s[60:63], s12 offen offset:2048 sc1 lds
    v_exp_f32 v74, v42
    v_exp_f32 v75, v43
    v_exp_f32 v76, v44
    v_smfmac_f32_16x16x64_bf16 v[112:115], v[250:253], v[48:55], v2
    v_exp_f32 v77, v45
    v_smfmac_f32_16x16x64_bf16 v[112:115], v[250:253], v[56:63], v2
    buffer_load_dwordx4 v4, s[60:63], s12 offen offset:3072 sc1 lds
    v_exp_f32 v78, v46
    v_exp_f32 v79, v47
    v_mfma_f32_32x32x16_bf16 v[32:47], v[140:143], v[132:135], 0
    ds_read_b128 v[148:151], v7 offset:4096
    ds_read_b128 v[152:155], v7 offset:5120
    v_exp_f32 v48, v16
    v_exp_f32 v49, v17
    v_exp_f32 v50, v18
    v_mfma_f32_32x32x16_bf16 v[32:47], v[144:147], v[136:139], v[32:47]
    ds_read_b128 v[164:167], v7 offset:6144
    ds_read_b128 v[168:171], v7 offset:7168
    v_exp_f32 v51, v19
    v_exp_f32 v52, v20
    v_exp_f32 v53, v21
    v_exp_f32 v54, v22
    v_smfmac_f32_32x32x32_bf16 v[96:111], v[156:159], v[64:71], v2
    v_exp_f32 v55, v23
    v_exp_f32 v56, v24
    v_exp_f32 v57, v25
    v_smfmac_f32_32x32x32_bf16 v[96:111], v[160:163], v[72:79], v2
    s_add_u32 m0, s37, 65536
    s_add_u32 s12, s37, 65536
    buffer_load_dwordx4 v4, s[60:63], s12 offen offset:0 sc1 lds
    v_exp_f32 v58, v26
    v_exp_f32 v59, v27
    v_exp_f32 v60, v28
    v_smfmac_f32_16x16x64_bf16 v[116:119], v[250:253], v[64:71], v2
    v_exp_f32 v61, v29
    v_smfmac_f32_16x16x64_bf16 v[116:119], v[250:253], v[72:79], v2
    buffer_load_dwordx4 v4, s[60:63], s12 offen offset:1024 sc1 lds
    v_exp_f32 v62, v30
    v_exp_f32 v63, v31
    s_waitcnt lgkmcnt(0)
    v_mfma_f32_32x32x16_bf16 v[16:31], v[148:151], v[124:127], 0
    v_exp_f32 v64, v32
    v_exp_f32 v65, v33
    v_exp_f32 v66, v34
    v_mfma_f32_32x32x16_bf16 v[16:31], v[152:155], v[128:131], v[16:31]
    v_exp_f32 v67, v35
    v_exp_f32 v68, v36
    v_exp_f32 v69, v37
    v_exp_f32 v70, v38
    v_smfmac_f32_32x32x32_bf16 v[80:95], v[164:167], v[48:55], v2
    v_exp_f32 v71, v39
    v_exp_f32 v72, v40
    v_exp_f32 v73, v41
    v_smfmac_f32_32x32x32_bf16 v[80:95], v[168:171], v[56:63], v2
    buffer_load_dwordx4 v4, s[60:63], s12 offen offset:2048 sc1 lds
    v_exp_f32 v74, v42
    v_exp_f32 v75, v43
    v_exp_f32 v76, v44
    v_smfmac_f32_16x16x64_bf16 v[112:115], v[250:253], v[48:55], v2
    v_exp_f32 v77, v45
    v_smfmac_f32_16x16x64_bf16 v[112:115], v[250:253], v[56:63], v2
    s_setprio 2
    buffer_load_dwordx4 v4, s[60:63], s12 offen offset:3072 sc1 lds
    v_exp_f32 v78, v46
    v_exp_f32 v79, v47
    v_mfma_f32_32x32x16_bf16 v[32:47], v[148:151], v[132:135], 0
    ds_read_b128 v[140:143], v7 offset:8192
    ds_read_b128 v[144:147], v7 offset:9216
    v_exp_f32 v48, v16
    v_exp_f32 v49, v17
    v_exp_f32 v50, v18
    v_mfma_f32_32x32x16_bf16 v[32:47], v[152:155], v[136:139], v[32:47]
    ds_read_b128 v[156:159], v7 offset:10240
    ds_read_b128 v[160:163], v7 offset:11264
    v_exp_f32 v51, v19
    v_exp_f32 v52, v20
    v_exp_f32 v53, v21
    v_exp_f32 v54, v22
    v_smfmac_f32_32x32x32_bf16 v[96:111], v[164:167], v[64:71], v2
    v_exp_f32 v55, v23
    v_exp_f32 v56, v24
    v_exp_f32 v57, v25
    v_smfmac_f32_32x32x32_bf16 v[96:111], v[168:171], v[72:79], v2
    buffer_load_dwordx4 v[172:175], v203, s[68:71], s38 offen
    s_add_u32 s38, s38, 7168
    v_exp_f32 v58, v26
    v_exp_f32 v59, v27
    v_exp_f32 v60, v28
    v_smfmac_f32_16x16x64_bf16 v[116:119], v[250:253], v[64:71], v2
    v_exp_f32 v61, v29
    v_smfmac_f32_16x16x64_bf16 v[116:119], v[250:253], v[72:79], v2
    v_exp_f32 v62, v30
    v_exp_f32 v63, v31
    s_waitcnt lgkmcnt(0)
    v_mfma_f32_32x32x16_bf16 v[16:31], v[140:143], v[124:127], 0
    v_exp_f32 v64, v32
    v_exp_f32 v65, v33
    v_exp_f32 v66, v34
    v_mfma_f32_32x32x16_bf16 v[16:31], v[144:147], v[128:131], v[16:31]
    v_exp_f32 v67, v35
    v_exp_f32 v68, v36
    v_exp_f32 v69, v37
    v_exp_f32 v70, v38
    v_smfmac_f32_32x32x32_bf16 v[80:95], v[156:159], v[48:55], v2
    v_exp_f32 v71, v39
    v_exp_f32 v72, v40
    v_exp_f32 v73, v41
    v_smfmac_f32_32x32x32_bf16 v[80:95], v[160:163], v[56:63], v2
    v_exp_f32 v74, v42
    v_exp_f32 v75, v43
    v_exp_f32 v76, v44
    v_smfmac_f32_16x16x64_bf16 v[112:115], v[250:253], v[48:55], v2
    v_exp_f32 v77, v45
    v_smfmac_f32_16x16x64_bf16 v[112:115], v[250:253], v[56:63], v2
    s_setprio 1
    v_exp_f32 v78, v46
    v_exp_f32 v79, v47
    v_mfma_f32_32x32x16_bf16 v[32:47], v[140:143], v[132:135], 0
    ds_read_b128 v[148:151], v7 offset:12288
    ds_read_b128 v[152:155], v7 offset:13312
    v_exp_f32 v48, v16
    v_exp_f32 v49, v17
    v_exp_f32 v50, v18
    v_mfma_f32_32x32x16_bf16 v[32:47], v[144:147], v[136:139], v[32:47]
    ds_read_b128 v[164:167], v7 offset:14336
    ds_read_b128 v[168:171], v7 offset:15360
    v_exp_f32 v51, v19
    v_exp_f32 v52, v20
    v_exp_f32 v53, v21
    v_exp_f32 v54, v22
    v_smfmac_f32_32x32x32_bf16 v[96:111], v[156:159], v[64:71], v2
    v_exp_f32 v55, v23
    v_exp_f32 v56, v24
    v_exp_f32 v57, v25
    v_smfmac_f32_32x32x32_bf16 v[96:111], v[160:163], v[72:79], v2
    v_exp_f32 v58, v26
    v_exp_f32 v59, v27
    v_exp_f32 v60, v28
    v_smfmac_f32_16x16x64_bf16 v[116:119], v[250:253], v[64:71], v2
    v_exp_f32 v61, v29
    v_smfmac_f32_16x16x64_bf16 v[116:119], v[250:253], v[72:79], v2
    s_setprio 0
    v_exp_f32 v62, v30
    v_exp_f32 v63, v31
    s_waitcnt lgkmcnt(0)
    v_mfma_f32_32x32x16_bf16 v[16:31], v[148:151], v[124:127], 0
    v_exp_f32 v64, v32
    v_exp_f32 v65, v33
    v_exp_f32 v66, v34
    v_mfma_f32_32x32x16_bf16 v[16:31], v[152:155], v[128:131], v[16:31]
    v_exp_f32 v67, v35
    v_exp_f32 v68, v36
    v_exp_f32 v69, v37
    v_exp_f32 v70, v38
    v_smfmac_f32_32x32x32_bf16 v[80:95], v[164:167], v[48:55], v2
    v_exp_f32 v71, v39
    v_exp_f32 v72, v40
    v_exp_f32 v73, v41
    v_smfmac_f32_32x32x32_bf16 v[80:95], v[168:171], v[56:63], v2
    buffer_load_dword v241, v241, s[60:63], 0 offen sc1
    v_exp_f32 v74, v42
    v_exp_f32 v75, v43
    v_exp_f32 v76, v44
    v_smfmac_f32_16x16x64_bf16 v[112:115], v[250:253], v[48:55], v2
    v_exp_f32 v77, v45
    v_smfmac_f32_16x16x64_bf16 v[112:115], v[250:253], v[56:63], v2
    buffer_store_dword v228, v6, s[60:63], 0 offen sc1
    s_waitcnt vmcnt(3)
    s_barrier
    s_setprio 3
    v_exp_f32 v78, v46
    v_exp_f32 v79, v47
    v_mfma_f32_32x32x16_bf16 v[32:47], v[148:151], v[132:135], 0
    ds_read_b128 v[140:143], v7 offset:32768
    ds_read_b128 v[144:147], v7 offset:33792
    v_exp_f32 v48, v16
    v_exp_f32 v49, v17
    v_exp_f32 v50, v18
    v_mfma_f32_32x32x16_bf16 v[32:47], v[152:155], v[136:139], v[32:47]
    ds_read_b128 v[156:159], v7 offset:34816
    ds_read_b128 v[160:163], v7 offset:35840
    v_exp_f32 v51, v19
    v_exp_f32 v52, v20
    v_exp_f32 v53, v21
    v_exp_f32 v54, v22
    v_smfmac_f32_32x32x32_bf16 v[96:111], v[164:167], v[64:71], v2
    v_exp_f32 v55, v23
    v_exp_f32 v56, v24
    v_exp_f32 v57, v25
    v_smfmac_f32_32x32x32_bf16 v[96:111], v[168:171], v[72:79], v2
    s_add_u32 m0, s37, 98304
    s_add_u32 s12, s37, 98304
    buffer_load_dwordx4 v4, s[60:63], s12 offen offset:0 sc1 lds
    v_exp_f32 v58, v26
    v_exp_f32 v59, v27
    v_exp_f32 v60, v28
    v_smfmac_f32_16x16x64_bf16 v[116:119], v[250:253], v[64:71], v2
    v_exp_f32 v61, v29
    v_smfmac_f32_16x16x64_bf16 v[116:119], v[250:253], v[72:79], v2
    buffer_load_dwordx4 v4, s[60:63], s12 offen offset:1024 sc1 lds
    v_exp_f32 v62, v30
    v_exp_f32 v63, v31
    s_waitcnt lgkmcnt(0)
    v_mfma_f32_32x32x16_bf16 v[16:31], v[140:143], v[124:127], 0
    v_exp_f32 v64, v32
    v_exp_f32 v65, v33
    v_exp_f32 v66, v34
    v_mfma_f32_32x32x16_bf16 v[16:31], v[144:147], v[128:131], v[16:31]
    v_exp_f32 v67, v35
    v_exp_f32 v68, v36
    v_exp_f32 v69, v37
    v_exp_f32 v70, v38
    v_smfmac_f32_32x32x32_bf16 v[80:95], v[156:159], v[48:55], v2
    v_exp_f32 v71, v39
    v_exp_f32 v72, v40
    v_exp_f32 v73, v41
    v_smfmac_f32_32x32x32_bf16 v[80:95], v[160:163], v[56:63], v2
    buffer_load_dwordx4 v4, s[60:63], s12 offen offset:2048 sc1 lds
    v_exp_f32 v74, v42
    v_exp_f32 v75, v43
    v_exp_f32 v76, v44
    v_smfmac_f32_16x16x64_bf16 v[112:115], v[250:253], v[48:55], v2
    v_exp_f32 v77, v45
    v_smfmac_f32_16x16x64_bf16 v[112:115], v[250:253], v[56:63], v2
    buffer_load_dwordx4 v4, s[60:63], s12 offen offset:3072 sc1 lds
    v_exp_f32 v78, v46
    v_exp_f32 v79, v47
    v_mfma_f32_32x32x16_bf16 v[32:47], v[140:143], v[132:135], 0
    ds_read_b128 v[148:151], v7 offset:36864
    ds_read_b128 v[152:155], v7 offset:37888
    v_exp_f32 v48, v16
    v_exp_f32 v49, v17
    v_exp_f32 v50, v18
    v_mfma_f32_32x32x16_bf16 v[32:47], v[144:147], v[136:139], v[32:47]
    ds_read_b128 v[164:167], v7 offset:38912
    ds_read_b128 v[168:171], v7 offset:39936
    v_exp_f32 v51, v19
    v_exp_f32 v52, v20
    v_exp_f32 v53, v21
    v_exp_f32 v54, v22
    v_smfmac_f32_32x32x32_bf16 v[96:111], v[156:159], v[64:71], v2
    v_exp_f32 v55, v23
    v_exp_f32 v56, v24
    v_exp_f32 v57, v25
    v_smfmac_f32_32x32x32_bf16 v[96:111], v[160:163], v[72:79], v2
    buffer_store_dwordx4 v[228:231], v5, s[60:63], 0 offen sc1
    v_exp_f32 v58, v26
    v_exp_f32 v59, v27
    v_exp_f32 v60, v28
    v_smfmac_f32_16x16x64_bf16 v[116:119], v[250:253], v[64:71], v2
    v_exp_f32 v61, v29
    v_smfmac_f32_16x16x64_bf16 v[116:119], v[250:253], v[72:79], v2
    buffer_load_dwordx2 v[204:205], v219, s[72:75], s39 offen offset:0
    v_exp_f32 v62, v30
    v_exp_f32 v63, v31
    s_waitcnt lgkmcnt(0)
    v_mfma_f32_32x32x16_bf16 v[16:31], v[148:151], v[124:127], 0
    v_exp_f32 v64, v32
    v_exp_f32 v65, v33
    v_exp_f32 v66, v34
    v_mfma_f32_32x32x16_bf16 v[16:31], v[152:155], v[128:131], v[16:31]
    v_exp_f32 v67, v35
    v_exp_f32 v68, v36
    v_exp_f32 v69, v37
    v_exp_f32 v70, v38
    v_smfmac_f32_32x32x32_bf16 v[80:95], v[164:167], v[48:55], v2
    v_exp_f32 v71, v39
    v_exp_f32 v72, v40
    v_exp_f32 v73, v41
    v_smfmac_f32_32x32x32_bf16 v[80:95], v[168:171], v[56:63], v2
    buffer_load_dwordx4 v[176:179], v203, s[68:71], s38 offen
    s_add_u32 s38, s38, 7168
    v_exp_f32 v74, v42
    v_exp_f32 v75, v43
    v_exp_f32 v76, v44
    v_smfmac_f32_16x16x64_bf16 v[112:115], v[250:253], v[48:55], v2
    v_exp_f32 v77, v45
    v_smfmac_f32_16x16x64_bf16 v[112:115], v[250:253], v[56:63], v2
    v_exp_f32 v78, v46
    v_exp_f32 v79, v47
    v_mfma_f32_32x32x16_bf16 v[32:47], v[148:151], v[132:135], 0
    ds_read_b128 v[140:143], v7 offset:40960
    ds_read_b128 v[144:147], v7 offset:41984
    v_exp_f32 v48, v16
    v_exp_f32 v49, v17
    v_exp_f32 v50, v18
    v_mfma_f32_32x32x16_bf16 v[32:47], v[152:155], v[136:139], v[32:47]
    ds_read_b128 v[156:159], v7 offset:43008
    ds_read_b128 v[160:163], v7 offset:44032
    v_exp_f32 v51, v19
    v_exp_f32 v52, v20
    v_exp_f32 v53, v21
    v_exp_f32 v54, v22
    v_smfmac_f32_32x32x32_bf16 v[96:111], v[164:167], v[64:71], v2
    v_exp_f32 v55, v23
    v_exp_f32 v56, v24
    v_exp_f32 v57, v25
    v_smfmac_f32_32x32x32_bf16 v[96:111], v[168:171], v[72:79], v2
    v_exp_f32 v58, v26
    v_exp_f32 v59, v27
    v_exp_f32 v60, v28
    v_smfmac_f32_16x16x64_bf16 v[116:119], v[250:253], v[64:71], v2
    v_exp_f32 v61, v29
    v_smfmac_f32_16x16x64_bf16 v[116:119], v[250:253], v[72:79], v2
    v_exp_f32 v62, v30
    v_exp_f32 v63, v31
    s_waitcnt lgkmcnt(0)
    v_mfma_f32_32x32x16_bf16 v[16:31], v[140:143], v[124:127], 0
    v_exp_f32 v64, v32
    v_exp_f32 v65, v33
    v_exp_f32 v66, v34
    v_mfma_f32_32x32x16_bf16 v[16:31], v[144:147], v[128:131], v[16:31]
    v_exp_f32 v67, v35
    v_exp_f32 v68, v36
    v_exp_f32 v69, v37
    v_exp_f32 v70, v38
    v_smfmac_f32_32x32x32_bf16 v[80:95], v[156:159], v[48:55], v2
    v_exp_f32 v71, v39
    v_exp_f32 v72, v40
    v_exp_f32 v73, v41
    v_smfmac_f32_32x32x32_bf16 v[80:95], v[160:163], v[56:63], v2
    v_exp_f32 v74, v42
    v_exp_f32 v75, v43
    v_exp_f32 v76, v44
    v_smfmac_f32_16x16x64_bf16 v[112:115], v[250:253], v[48:55], v2
    v_exp_f32 v77, v45
    v_smfmac_f32_16x16x64_bf16 v[112:115], v[250:253], v[56:63], v2
    v_exp_f32 v78, v46
    v_exp_f32 v79, v47
    v_mfma_f32_32x32x16_bf16 v[32:47], v[140:143], v[132:135], 0
    ds_read_b128 v[148:151], v7 offset:45056
    ds_read_b128 v[152:155], v7 offset:46080
    v_exp_f32 v48, v16
    v_exp_f32 v49, v17
    v_exp_f32 v50, v18
    v_mfma_f32_32x32x16_bf16 v[32:47], v[144:147], v[136:139], v[32:47]
    ds_read_b128 v[164:167], v7 offset:47104
    ds_read_b128 v[168:171], v7 offset:48128
    v_exp_f32 v51, v19
    v_exp_f32 v52, v20
    v_exp_f32 v53, v21
    v_exp_f32 v54, v22
    v_smfmac_f32_32x32x32_bf16 v[96:111], v[156:159], v[64:71], v2
    v_exp_f32 v55, v23
    v_exp_f32 v56, v24
    v_exp_f32 v57, v25
    v_smfmac_f32_32x32x32_bf16 v[96:111], v[160:163], v[72:79], v2
    s_add_u32 m0, s37, 0
    s_add_u32 s12, s37, 131072
    buffer_load_dwordx4 v4, s[60:63], s12 offen offset:0 sc1 lds
    v_exp_f32 v58, v26
    v_exp_f32 v59, v27
    v_exp_f32 v60, v28
    v_smfmac_f32_16x16x64_bf16 v[116:119], v[250:253], v[64:71], v2
    v_exp_f32 v61, v29
    v_smfmac_f32_16x16x64_bf16 v[116:119], v[250:253], v[72:79], v2
    buffer_load_dwordx4 v4, s[60:63], s12 offen offset:1024 sc1 lds
    v_exp_f32 v62, v30
    v_exp_f32 v63, v31
    s_waitcnt lgkmcnt(0)
    v_mfma_f32_32x32x16_bf16 v[16:31], v[148:151], v[124:127], 0
    v_exp_f32 v64, v32
    v_exp_f32 v65, v33
    v_exp_f32 v66, v34
    v_mfma_f32_32x32x16_bf16 v[16:31], v[152:155], v[128:131], v[16:31]
    v_exp_f32 v67, v35
    v_exp_f32 v68, v36
    v_exp_f32 v69, v37
    v_exp_f32 v70, v38
    v_smfmac_f32_32x32x32_bf16 v[80:95], v[164:167], v[48:55], v2
    v_exp_f32 v71, v39
    v_exp_f32 v72, v40
    v_exp_f32 v73, v41
    v_smfmac_f32_32x32x32_bf16 v[80:95], v[168:171], v[56:63], v2
    buffer_load_dwordx4 v4, s[60:63], s12 offen offset:2048 sc1 lds
    v_exp_f32 v74, v42
    v_exp_f32 v75, v43
    v_exp_f32 v76, v44
    v_smfmac_f32_16x16x64_bf16 v[112:115], v[250:253], v[48:55], v2
    v_exp_f32 v77, v45
    v_smfmac_f32_16x16x64_bf16 v[112:115], v[250:253], v[56:63], v2
    s_setprio 2
    buffer_load_dwordx4 v4, s[60:63], s12 offen offset:3072 sc1 lds
    v_exp_f32 v78, v46
    v_exp_f32 v79, v47
    v_mfma_f32_32x32x16_bf16 v[32:47], v[148:151], v[132:135], 0
    ds_read_b128 v[140:143], v244 offset:0
    ds_read_b128 v[144:147], v244 offset:1024
    v_exp_f32 v48, v16
    v_exp_f32 v49, v17
    v_exp_f32 v50, v18
    v_mfma_f32_32x32x16_bf16 v[32:47], v[152:155], v[136:139], v[32:47]
    ds_read_b128 v[156:159], v244 offset:2048
    ds_read_b128 v[160:163], v244 offset:3072
    v_exp_f32 v51, v19
    v_exp_f32 v52, v20
    v_exp_f32 v53, v21
    v_exp_f32 v54, v22
    v_smfmac_f32_32x32x32_bf16 v[96:111], v[164:167], v[64:71], v2
    v_exp_f32 v55, v23
    v_exp_f32 v56, v24
    v_exp_f32 v57, v25
    v_smfmac_f32_32x32x32_bf16 v[96:111], v[168:171], v[72:79], v2
    buffer_load_dwordx2 v[206:207], v219, s[72:75], s39 offen offset:2048
    s_add_u32 s39, s39, 4096
    v_exp_f32 v58, v26
    v_exp_f32 v59, v27
    v_exp_f32 v60, v28
    v_smfmac_f32_16x16x64_bf16 v[116:119], v[250:253], v[64:71], v2
    v_exp_f32 v61, v29
    v_smfmac_f32_16x16x64_bf16 v[116:119], v[250:253], v[72:79], v2
    buffer_load_dwordx2 v[208:209], v219, s[72:75], s39 offen offset:0
    v_exp_f32 v62, v30
    v_exp_f32 v63, v31
    s_waitcnt lgkmcnt(0)
    v_mfma_f32_32x32x16_bf16 v[16:31], v[140:143], v[124:127], 0
    v_exp_f32 v64, v32
    v_exp_f32 v65, v33
    v_exp_f32 v66, v34
    v_mfma_f32_32x32x16_bf16 v[16:31], v[144:147], v[128:131], v[16:31]
    v_exp_f32 v67, v35
    v_exp_f32 v68, v36
    v_exp_f32 v69, v37
    v_exp_f32 v70, v38
    v_smfmac_f32_32x32x32_bf16 v[80:95], v[156:159], v[48:55], v2
    v_exp_f32 v71, v39
    v_exp_f32 v72, v40
    v_exp_f32 v73, v41
    v_smfmac_f32_32x32x32_bf16 v[80:95], v[160:163], v[56:63], v2
    buffer_load_dwordx4 v[180:183], v203, s[68:71], s38 offen
    s_add_u32 s38, s38, 7168
    v_exp_f32 v74, v42
    v_exp_f32 v75, v43
    v_exp_f32 v76, v44
    v_smfmac_f32_16x16x64_bf16 v[112:115], v[250:253], v[48:55], v2
    v_exp_f32 v77, v45
    v_smfmac_f32_16x16x64_bf16 v[112:115], v[250:253], v[56:63], v2
    v_exp_f32 v78, v46
    v_exp_f32 v79, v47
    v_mfma_f32_32x32x16_bf16 v[32:47], v[140:143], v[132:135], 0
    ds_read_b128 v[148:151], v244 offset:4096
    ds_read_b128 v[152:155], v244 offset:5120
    v_exp_f32 v48, v16
    v_exp_f32 v49, v17
    v_exp_f32 v50, v18
    v_mfma_f32_32x32x16_bf16 v[32:47], v[144:147], v[136:139], v[32:47]
    ds_read_b128 v[164:167], v244 offset:6144
    ds_read_b128 v[168:171], v244 offset:7168
    v_exp_f32 v51, v19
    v_exp_f32 v52, v20
    v_exp_f32 v53, v21
    v_exp_f32 v54, v22
    v_smfmac_f32_32x32x32_bf16 v[96:111], v[156:159], v[64:71], v2
    v_exp_f32 v55, v23
    v_exp_f32 v56, v24
    v_exp_f32 v57, v25
    v_smfmac_f32_32x32x32_bf16 v[96:111], v[160:163], v[72:79], v2
    v_exp_f32 v58, v26
    v_exp_f32 v59, v27
    v_exp_f32 v60, v28
    v_smfmac_f32_16x16x64_bf16 v[116:119], v[250:253], v[64:71], v2
    v_exp_f32 v61, v29
    v_smfmac_f32_16x16x64_bf16 v[116:119], v[250:253], v[72:79], v2
    v_exp_f32 v62, v30
    v_exp_f32 v63, v31
    s_waitcnt lgkmcnt(0)
    v_mfma_f32_32x32x16_bf16 v[16:31], v[148:151], v[124:127], 0
    v_exp_f32 v64, v32
    v_exp_f32 v65, v33
    v_exp_f32 v66, v34
    v_mfma_f32_32x32x16_bf16 v[16:31], v[152:155], v[128:131], v[16:31]
    v_exp_f32 v67, v35
    v_exp_f32 v68, v36
    v_exp_f32 v69, v37
    v_exp_f32 v70, v38
    v_smfmac_f32_32x32x32_bf16 v[80:95], v[164:167], v[48:55], v2
    v_exp_f32 v71, v39
    v_exp_f32 v72, v40
    v_exp_f32 v73, v41
    v_smfmac_f32_32x32x32_bf16 v[80:95], v[168:171], v[56:63], v2
    v_exp_f32 v74, v42
    v_exp_f32 v75, v43
    v_exp_f32 v76, v44
    v_smfmac_f32_16x16x64_bf16 v[112:115], v[250:253], v[48:55], v2
    v_exp_f32 v77, v45
    v_smfmac_f32_16x16x64_bf16 v[112:115], v[250:253], v[56:63], v2
    s_setprio 1
    v_exp_f32 v78, v46
    v_exp_f32 v79, v47
    v_mfma_f32_32x32x16_bf16 v[32:47], v[148:151], v[132:135], 0
    ds_read_b128 v[140:143], v244 offset:8192
    ds_read_b128 v[144:147], v244 offset:9216
    v_exp_f32 v48, v16
    v_exp_f32 v49, v17
    v_exp_f32 v50, v18
    v_mfma_f32_32x32x16_bf16 v[32:47], v[152:155], v[136:139], v[32:47]
    ds_read_b128 v[156:159], v244 offset:10240
    ds_read_b128 v[160:163], v244 offset:11264
    v_exp_f32 v51, v19
    v_exp_f32 v52, v20
    v_exp_f32 v53, v21
    v_exp_f32 v54, v22
    v_smfmac_f32_32x32x32_bf16 v[96:111], v[164:167], v[64:71], v2
    v_exp_f32 v55, v23
    v_exp_f32 v56, v24
    v_exp_f32 v57, v25
    v_smfmac_f32_32x32x32_bf16 v[96:111], v[168:171], v[72:79], v2
    s_add_u32 m0, s37, 32768
    s_add_u32 s12, s90, 0
    buffer_load_dwordx4 v236, s[56:59], s12 offen offset:0 lds
    v_exp_f32 v58, v26
    v_exp_f32 v59, v27
    v_exp_f32 v60, v28
    v_smfmac_f32_16x16x64_bf16 v[116:119], v[250:253], v[64:71], v2
    v_exp_f32 v61, v29
    v_smfmac_f32_16x16x64_bf16 v[116:119], v[250:253], v[72:79], v2
    buffer_load_dwordx2 v[210:211], v219, s[72:75], s39 offen offset:2048
    s_add_u32 s39, s39, 4096
    v_exp_f32 v62, v30
    v_exp_f32 v63, v31
    s_waitcnt lgkmcnt(0)
    v_mfma_f32_32x32x16_bf16 v[16:31], v[140:143], v[124:127], 0
    v_exp_f32 v64, v32
    v_exp_f32 v65, v33
    v_exp_f32 v66, v34
    v_mfma_f32_32x32x16_bf16 v[16:31], v[144:147], v[128:131], v[16:31]
    v_exp_f32 v67, v35
    v_exp_f32 v68, v36
    v_exp_f32 v69, v37
    v_exp_f32 v70, v38
    v_smfmac_f32_32x32x32_bf16 v[80:95], v[156:159], v[48:55], v2
    v_exp_f32 v71, v39
    v_exp_f32 v72, v40
    v_exp_f32 v73, v41
    v_smfmac_f32_32x32x32_bf16 v[80:95], v[160:163], v[56:63], v2
    buffer_load_dwordx4 v237, s[56:59], s12 offen offset:1024 lds
    v_exp_f32 v74, v42
    v_exp_f32 v75, v43
    v_exp_f32 v76, v44
    v_smfmac_f32_16x16x64_bf16 v[112:115], v[250:253], v[48:55], v2
    v_exp_f32 v77, v45
    v_smfmac_f32_16x16x64_bf16 v[112:115], v[250:253], v[56:63], v2
    s_setprio 0
    buffer_load_dwordx2 v[212:213], v219, s[72:75], s39 offen offset:0
    v_exp_f32 v78, v46
    v_exp_f32 v79, v47
    v_mfma_f32_32x32x16_bf16 v[32:47], v[140:143], v[132:135], 0
    ds_read_b128 v[148:151], v244 offset:12288
    ds_read_b128 v[152:155], v244 offset:13312
    v_exp_f32 v48, v16
    v_exp_f32 v49, v17
    v_exp_f32 v50, v18
    v_mfma_f32_32x32x16_bf16 v[32:47], v[144:147], v[136:139], v[32:47]
    ds_read_b128 v[164:167], v244 offset:14336
    ds_read_b128 v[168:171], v244 offset:15360
    v_exp_f32 v51, v19
    v_exp_f32 v52, v20
    v_exp_f32 v53, v21
    v_exp_f32 v54, v22
    v_smfmac_f32_32x32x32_bf16 v[96:111], v[156:159], v[64:71], v2
    v_exp_f32 v55, v23
    v_exp_f32 v56, v24
    v_exp_f32 v57, v25
    v_smfmac_f32_32x32x32_bf16 v[96:111], v[160:163], v[72:79], v2
    buffer_load_dwordx4 v238, s[56:59], s12 offen offset:2048 lds
    v_exp_f32 v58, v26
    v_exp_f32 v59, v27
    v_exp_f32 v60, v28
    v_smfmac_f32_16x16x64_bf16 v[116:119], v[250:253], v[64:71], v2
    v_exp_f32 v61, v29
    v_smfmac_f32_16x16x64_bf16 v[116:119], v[250:253], v[72:79], v2
    buffer_load_dwordx2 v[214:215], v219, s[72:75], s39 offen offset:2048
    s_add_u32 s39, s39, 4096
    v_exp_f32 v62, v30
    v_exp_f32 v63, v31
    s_waitcnt lgkmcnt(0)
    v_mfma_f32_32x32x16_bf16 v[16:31], v[148:151], v[124:127], 0
    v_exp_f32 v64, v32
    v_exp_f32 v65, v33
    v_exp_f32 v66, v34
    v_mfma_f32_32x32x16_bf16 v[16:31], v[152:155], v[128:131], v[16:31]
    v_exp_f32 v67, v35
    v_exp_f32 v68, v36
    v_exp_f32 v69, v37
    v_exp_f32 v70, v38
    v_smfmac_f32_32x32x32_bf16 v[80:95], v[164:167], v[48:55], v2
    v_exp_f32 v71, v39
    v_exp_f32 v72, v40
    v_exp_f32 v73, v41
    v_smfmac_f32_32x32x32_bf16 v[80:95], v[168:171], v[56:63], v2
    buffer_load_dwordx4 v239, s[56:59], s12 offen offset:3072 lds
    v_exp_f32 v74, v42
    v_exp_f32 v75, v43
    v_exp_f32 v76, v44
    v_smfmac_f32_16x16x64_bf16 v[112:115], v[250:253], v[48:55], v2
    v_exp_f32 v77, v45
    v_smfmac_f32_16x16x64_bf16 v[112:115], v[250:253], v[56:63], v2
    buffer_load_dwordx2 v[216:217], v219, s[72:75], s39 offen offset:0
    s_waitcnt vmcnt(11)
    s_barrier
    s_setprio 3
    v_exp_f32 v78, v46
    v_exp_f32 v79, v47
    v_mfma_f32_32x32x16_bf16 v[32:47], v[148:151], v[132:135], 0
    ds_read_b128 v[140:143], v7 offset:0
    ds_read_b128 v[144:147], v7 offset:1024
    v_exp_f32 v48, v16
    v_exp_f32 v49, v17
    v_exp_f32 v50, v18
    v_mfma_f32_32x32x16_bf16 v[32:47], v[152:155], v[136:139], v[32:47]
    ds_read_b128 v[156:159], v7 offset:2048
    ds_read_b128 v[160:163], v7 offset:3072
    v_exp_f32 v51, v19
    v_exp_f32 v52, v20
    v_exp_f32 v53, v21
    v_exp_f32 v54, v22
    v_smfmac_f32_32x32x32_bf16 v[96:111], v[164:167], v[64:71], v2
    v_exp_f32 v55, v23
    v_exp_f32 v56, v24
    v_exp_f32 v57, v25
    v_smfmac_f32_32x32x32_bf16 v[96:111], v[168:171], v[72:79], v2
    buffer_load_dwordx4 v[184:187], v203, s[68:71], s38 offen
    s_add_u32 s38, s38, 7168
    v_exp_f32 v58, v26
    v_exp_f32 v59, v27
    v_exp_f32 v60, v28
    v_smfmac_f32_16x16x64_bf16 v[116:119], v[250:253], v[64:71], v2
    v_exp_f32 v61, v29
    v_smfmac_f32_16x16x64_bf16 v[116:119], v[250:253], v[72:79], v2
    v_exp_f32 v62, v30
    v_exp_f32 v63, v31
    s_waitcnt lgkmcnt(0)
    v_mfma_f32_32x32x16_bf16 v[16:31], v[140:143], v[124:127], 0
    v_exp_f32 v64, v32
    v_exp_f32 v65, v33
    v_exp_f32 v66, v34
    v_mfma_f32_32x32x16_bf16 v[16:31], v[144:147], v[128:131], v[16:31]
    v_exp_f32 v67, v35
    v_exp_f32 v68, v36
    v_exp_f32 v69, v37
    v_exp_f32 v70, v38
    v_smfmac_f32_32x32x32_bf16 v[80:95], v[156:159], v[48:55], v2
    v_exp_f32 v71, v39
    v_exp_f32 v72, v40
    v_exp_f32 v73, v41
    v_smfmac_f32_32x32x32_bf16 v[80:95], v[160:163], v[56:63], v2
    v_exp_f32 v74, v42
    v_exp_f32 v75, v43
    v_exp_f32 v76, v44
    v_smfmac_f32_16x16x64_bf16 v[112:115], v[250:253], v[48:55], v2
    v_exp_f32 v77, v45
    v_smfmac_f32_16x16x64_bf16 v[112:115], v[250:253], v[56:63], v2
    v_exp_f32 v78, v46
    v_exp_f32 v79, v47
    v_mfma_f32_32x32x16_bf16 v[32:47], v[140:143], v[132:135], 0
    ds_read_b128 v[148:151], v7 offset:4096
    ds_read_b128 v[152:155], v7 offset:5120
    v_exp_f32 v48, v16
    v_exp_f32 v49, v17
    v_exp_f32 v50, v18
    v_mfma_f32_32x32x16_bf16 v[32:47], v[144:147], v[136:139], v[32:47]
    ds_read_b128 v[164:167], v7 offset:6144
    ds_read_b128 v[168:171], v7 offset:7168
    v_exp_f32 v51, v19
    v_exp_f32 v52, v20
    v_exp_f32 v53, v21
    v_exp_f32 v54, v22
    v_smfmac_f32_32x32x32_bf16 v[96:111], v[156:159], v[64:71], v2
    v_exp_f32 v55, v23
    v_exp_f32 v56, v24
    v_exp_f32 v57, v25
    v_smfmac_f32_32x32x32_bf16 v[96:111], v[160:163], v[72:79], v2
    v_exp_f32 v58, v26
    v_exp_f32 v59, v27
    v_exp_f32 v60, v28
    v_smfmac_f32_16x16x64_bf16 v[116:119], v[250:253], v[64:71], v2
    v_exp_f32 v61, v29
    v_smfmac_f32_16x16x64_bf16 v[116:119], v[250:253], v[72:79], v2
    v_exp_f32 v62, v30
    v_exp_f32 v63, v31
    s_waitcnt lgkmcnt(0)
    v_mfma_f32_32x32x16_bf16 v[16:31], v[148:151], v[124:127], 0
    v_exp_f32 v64, v32
    v_exp_f32 v65, v33
    v_exp_f32 v66, v34
    v_mfma_f32_32x32x16_bf16 v[16:31], v[152:155], v[128:131], v[16:31]
    v_exp_f32 v67, v35
    v_exp_f32 v68, v36
    v_exp_f32 v69, v37
    v_exp_f32 v70, v38
    v_smfmac_f32_32x32x32_bf16 v[80:95], v[164:167], v[48:55], v2
    v_exp_f32 v71, v39
    v_exp_f32 v72, v40
    v_exp_f32 v73, v41
    v_smfmac_f32_32x32x32_bf16 v[80:95], v[168:171], v[56:63], v2
    s_add_u32 m0, s37, 131072
    s_add_u32 s12, s37, 163840
    buffer_load_dwordx4 v4, s[60:63], s12 offen offset:0 sc1 lds
    v_exp_f32 v74, v42
    v_exp_f32 v75, v43
    v_exp_f32 v76, v44
    v_smfmac_f32_16x16x64_bf16 v[112:115], v[250:253], v[48:55], v2
    v_exp_f32 v77, v45
    v_smfmac_f32_16x16x64_bf16 v[112:115], v[250:253], v[56:63], v2
    buffer_load_dwordx4 v4, s[60:63], s12 offen offset:1024 sc1 lds
    v_exp_f32 v78, v46
    v_exp_f32 v79, v47
    v_mfma_f32_32x32x16_bf16 v[32:47], v[148:151], v[132:135], 0
    ds_read_b128 v[140:143], v7 offset:8192
    ds_read_b128 v[144:147], v7 offset:9216
    v_exp_f32 v48, v16
    v_exp_f32 v49, v17
    v_exp_f32 v50, v18
    v_mfma_f32_32x32x16_bf16 v[32:47], v[152:155], v[136:139], v[32:47]
    ds_read_b128 v[156:159], v7 offset:10240
    ds_read_b128 v[160:163], v7 offset:11264
    v_exp_f32 v51, v19
    v_exp_f32 v52, v20
    v_exp_f32 v53, v21
    v_exp_f32 v54, v22
    v_smfmac_f32_32x32x32_bf16 v[96:111], v[164:167], v[64:71], v2
    v_exp_f32 v55, v23
    v_exp_f32 v56, v24
    v_exp_f32 v57, v25
    v_smfmac_f32_32x32x32_bf16 v[96:111], v[168:171], v[72:79], v2
    buffer_load_dwordx4 v4, s[60:63], s12 offen offset:2048 sc1 lds
    v_exp_f32 v58, v26
    v_exp_f32 v59, v27
    v_exp_f32 v60, v28
    v_smfmac_f32_16x16x64_bf16 v[116:119], v[250:253], v[64:71], v2
    v_exp_f32 v61, v29
    v_smfmac_f32_16x16x64_bf16 v[116:119], v[250:253], v[72:79], v2
    buffer_load_dwordx4 v4, s[60:63], s12 offen offset:3072 sc1 lds
    v_exp_f32 v62, v30
    v_exp_f32 v63, v31
    s_waitcnt lgkmcnt(0)
    v_mfma_f32_32x32x16_bf16 v[16:31], v[140:143], v[124:127], 0
    v_exp_f32 v64, v32
    v_exp_f32 v65, v33
    v_exp_f32 v66, v34
    v_mfma_f32_32x32x16_bf16 v[16:31], v[144:147], v[128:131], v[16:31]
    v_exp_f32 v67, v35
    v_exp_f32 v68, v36
    v_exp_f32 v69, v37
    v_exp_f32 v70, v38
    v_smfmac_f32_32x32x32_bf16 v[80:95], v[156:159], v[48:55], v2
    v_exp_f32 v71, v39
    v_exp_f32 v72, v40
    v_exp_f32 v73, v41
    v_smfmac_f32_32x32x32_bf16 v[80:95], v[160:163], v[56:63], v2
    buffer_load_dwordx2 v[218:219], v219, s[72:75], s39 offen offset:2048
    s_add_u32 s39, s39, 4096
    v_exp_f32 v74, v42
    v_exp_f32 v75, v43
    v_exp_f32 v76, v44
    v_smfmac_f32_16x16x64_bf16 v[112:115], v[250:253], v[48:55], v2
    v_exp_f32 v77, v45
    v_smfmac_f32_16x16x64_bf16 v[112:115], v[250:253], v[56:63], v2
    buffer_load_dwordx2 v[220:221], v227, s[44:47], s91 offen offset:0
    v_exp_f32 v78, v46
    v_exp_f32 v79, v47
    v_mfma_f32_32x32x16_bf16 v[32:47], v[140:143], v[132:135], 0
    ds_read_b128 v[148:151], v7 offset:12288
    ds_read_b128 v[152:155], v7 offset:13312
    v_exp_f32 v48, v16
    v_exp_f32 v49, v17
    v_exp_f32 v50, v18
    v_mfma_f32_32x32x16_bf16 v[32:47], v[144:147], v[136:139], v[32:47]
    ds_read_b128 v[164:167], v7 offset:14336
    ds_read_b128 v[168:171], v7 offset:15360
    v_exp_f32 v51, v19
    v_exp_f32 v52, v20
    v_exp_f32 v53, v21
    v_exp_f32 v54, v22
    v_smfmac_f32_32x32x32_bf16 v[96:111], v[156:159], v[64:71], v2
    v_exp_f32 v55, v23
    v_exp_f32 v56, v24
    v_exp_f32 v57, v25
    v_smfmac_f32_32x32x32_bf16 v[96:111], v[160:163], v[72:79], v2
    buffer_load_dwordx4 v[188:191], v203, s[68:71], s38 offen
    s_add_u32 s38, s38, 7168
    v_exp_f32 v58, v26
    v_exp_f32 v59, v27
    v_exp_f32 v60, v28
    v_smfmac_f32_16x16x64_bf16 v[116:119], v[250:253], v[64:71], v2
    v_exp_f32 v61, v29
    v_smfmac_f32_16x16x64_bf16 v[116:119], v[250:253], v[72:79], v2
    v_exp_f32 v62, v30
    v_exp_f32 v63, v31
    s_waitcnt lgkmcnt(0)
    v_mfma_f32_32x32x16_bf16 v[16:31], v[148:151], v[124:127], 0
    v_exp_f32 v64, v32
    v_exp_f32 v65, v33
    v_exp_f32 v66, v34
    v_mfma_f32_32x32x16_bf16 v[16:31], v[152:155], v[128:131], v[16:31]
    v_exp_f32 v67, v35
    v_exp_f32 v68, v36
    v_exp_f32 v69, v37
    v_exp_f32 v70, v38
    v_smfmac_f32_32x32x32_bf16 v[80:95], v[164:167], v[48:55], v2
    v_exp_f32 v71, v39
    v_exp_f32 v72, v40
    v_exp_f32 v73, v41
    v_smfmac_f32_32x32x32_bf16 v[80:95], v[168:171], v[56:63], v2
    v_exp_f32 v74, v42
    v_exp_f32 v75, v43
    v_exp_f32 v76, v44
    v_smfmac_f32_16x16x64_bf16 v[112:115], v[250:253], v[48:55], v2
    v_exp_f32 v77, v45
    v_smfmac_f32_16x16x64_bf16 v[112:115], v[250:253], v[56:63], v2
    s_setprio 2
    v_exp_f32 v78, v46
    v_exp_f32 v79, v47
    v_mfma_f32_32x32x16_bf16 v[32:47], v[148:151], v[132:135], 0
    ds_read_b128 v[140:143], v3 offset:0
    ds_read_b128 v[144:147], v3 offset:1024
    v_exp_f32 v48, v16
    v_exp_f32 v49, v17
    v_exp_f32 v50, v18
    v_mfma_f32_32x32x16_bf16 v[32:47], v[152:155], v[136:139], v[32:47]
    ds_read_b128 v[156:159], v3 offset:2048
    ds_read_b128 v[160:163], v3 offset:3072
    v_exp_f32 v51, v19
    v_exp_f32 v52, v20
    v_exp_f32 v53, v21
    v_exp_f32 v54, v22
    v_smfmac_f32_32x32x32_bf16 v[96:111], v[164:167], v[64:71], v2
    v_exp_f32 v55, v23
    v_exp_f32 v56, v24
    v_exp_f32 v57, v25
    v_smfmac_f32_32x32x32_bf16 v[96:111], v[168:171], v[72:79], v2
    v_exp_f32 v58, v26
    v_exp_f32 v59, v27
    v_exp_f32 v60, v28
    v_smfmac_f32_16x16x64_bf16 v[116:119], v[250:253], v[64:71], v2
    v_exp_f32 v61, v29
    v_smfmac_f32_16x16x64_bf16 v[116:119], v[250:253], v[72:79], v2
    v_exp_f32 v62, v30
    v_exp_f32 v63, v31
    s_waitcnt lgkmcnt(0)
    v_mfma_f32_32x32x16_bf16 v[16:31], v[140:143], v[124:127], 0
    v_exp_f32 v64, v32
    v_exp_f32 v65, v33
    v_exp_f32 v66, v34
    v_mfma_f32_32x32x16_bf16 v[16:31], v[144:147], v[128:131], v[16:31]
    v_exp_f32 v67, v35
    v_exp_f32 v68, v36
    v_exp_f32 v69, v37
    v_exp_f32 v70, v38
    v_smfmac_f32_32x32x32_bf16 v[80:95], v[156:159], v[48:55], v2
    v_exp_f32 v71, v39
    v_exp_f32 v72, v40
    v_exp_f32 v73, v41
    v_smfmac_f32_32x32x32_bf16 v[80:95], v[160:163], v[56:63], v2
    s_add_u32 m0, s37, 65536
    s_add_u32 s12, s37, 196608
    buffer_load_dwordx4 v4, s[60:63], s12 offen offset:0 sc1 lds
    v_exp_f32 v74, v42
    v_exp_f32 v75, v43
    v_exp_f32 v76, v44
    v_smfmac_f32_16x16x64_bf16 v[112:115], v[250:253], v[48:55], v2
    v_exp_f32 v77, v45
    v_smfmac_f32_16x16x64_bf16 v[112:115], v[250:253], v[56:63], v2
    buffer_load_dwordx4 v4, s[60:63], s12 offen offset:1024 sc1 lds
    v_exp_f32 v78, v46
    v_exp_f32 v79, v47
    v_mfma_f32_32x32x16_bf16 v[32:47], v[140:143], v[132:135], 0
    ds_read_b128 v[148:151], v3 offset:4096
    ds_read_b128 v[152:155], v3 offset:5120
    v_exp_f32 v48, v16
    v_exp_f32 v49, v17
    v_exp_f32 v50, v18
    v_mfma_f32_32x32x16_bf16 v[32:47], v[144:147], v[136:139], v[32:47]
    ds_read_b128 v[164:167], v3 offset:6144
    ds_read_b128 v[168:171], v3 offset:7168
    v_exp_f32 v51, v19
    v_exp_f32 v52, v20
    v_exp_f32 v53, v21
    v_exp_f32 v54, v22
    v_smfmac_f32_32x32x32_bf16 v[96:111], v[156:159], v[64:71], v2
    v_exp_f32 v55, v23
    v_exp_f32 v56, v24
    v_exp_f32 v57, v25
    v_smfmac_f32_32x32x32_bf16 v[96:111], v[160:163], v[72:79], v2
    buffer_load_dwordx4 v4, s[60:63], s12 offen offset:2048 sc1 lds
    v_exp_f32 v58, v26
    v_exp_f32 v59, v27
    v_exp_f32 v60, v28
    v_smfmac_f32_16x16x64_bf16 v[116:119], v[250:253], v[64:71], v2
    v_exp_f32 v61, v29
    v_smfmac_f32_16x16x64_bf16 v[116:119], v[250:253], v[72:79], v2
    buffer_load_dwordx4 v4, s[60:63], s12 offen offset:3072 sc1 lds
    v_exp_f32 v62, v30
    v_exp_f32 v63, v31
    s_waitcnt lgkmcnt(0)
    v_mfma_f32_32x32x16_bf16 v[16:31], v[148:151], v[124:127], 0
    v_exp_f32 v64, v32
    v_exp_f32 v65, v33
    v_exp_f32 v66, v34
    v_mfma_f32_32x32x16_bf16 v[16:31], v[152:155], v[128:131], v[16:31]
    v_exp_f32 v67, v35
    v_exp_f32 v68, v36
    v_exp_f32 v69, v37
    v_exp_f32 v70, v38
    v_smfmac_f32_32x32x32_bf16 v[80:95], v[164:167], v[48:55], v2
    v_exp_f32 v71, v39
    v_exp_f32 v72, v40
    v_exp_f32 v73, v41
    v_smfmac_f32_32x32x32_bf16 v[80:95], v[168:171], v[56:63], v2
    buffer_load_dwordx2 v[222:223], v227, s[44:47], s91 offen offset:32
    v_exp_f32 v74, v42
    v_exp_f32 v75, v43
    v_exp_f32 v76, v44
    v_smfmac_f32_16x16x64_bf16 v[112:115], v[250:253], v[48:55], v2
    v_exp_f32 v77, v45
    v_smfmac_f32_16x16x64_bf16 v[112:115], v[250:253], v[56:63], v2
    s_setprio 1
    buffer_load_dwordx2 v[224:225], v227, s[44:47], s91 offen offset:64
    v_exp_f32 v78, v46
    v_exp_f32 v79, v47
    v_mfma_f32_32x32x16_bf16 v[32:47], v[148:151], v[132:135], 0
    ds_read_b128 v[140:143], v3 offset:8192
    ds_read_b128 v[144:147], v3 offset:9216
    v_exp_f32 v48, v16
    v_exp_f32 v49, v17
    v_exp_f32 v50, v18
    v_mfma_f32_32x32x16_bf16 v[32:47], v[152:155], v[136:139], v[32:47]
    ds_read_b128 v[156:159], v3 offset:10240
    ds_read_b128 v[160:163], v3 offset:11264
    v_exp_f32 v51, v19
    v_exp_f32 v52, v20
    v_exp_f32 v53, v21
    v_exp_f32 v54, v22
    v_smfmac_f32_32x32x32_bf16 v[96:111], v[164:167], v[64:71], v2
    v_exp_f32 v55, v23
    v_exp_f32 v56, v24
    v_exp_f32 v57, v25
    v_smfmac_f32_32x32x32_bf16 v[96:111], v[168:171], v[72:79], v2
    buffer_load_dwordx2 v[226:227], v227, s[44:47], s91 offen offset:96
    v_exp_f32 v58, v26
    v_exp_f32 v59, v27
    v_exp_f32 v60, v28
    v_smfmac_f32_16x16x64_bf16 v[116:119], v[250:253], v[64:71], v2
    v_exp_f32 v61, v29
    v_smfmac_f32_16x16x64_bf16 v[116:119], v[250:253], v[72:79], v2
    buffer_load_dwordx2 v[228:229], v240, s[76:79], s92 offen offset:0
    v_exp_f32 v62, v30
    v_exp_f32 v63, v31
    s_waitcnt lgkmcnt(0)
    v_mfma_f32_32x32x16_bf16 v[16:31], v[140:143], v[124:127], 0
    v_exp_f32 v64, v32
    v_exp_f32 v65, v33
    v_exp_f32 v66, v34
    v_mfma_f32_32x32x16_bf16 v[16:31], v[144:147], v[128:131], v[16:31]
    v_exp_f32 v67, v35
    v_exp_f32 v68, v36
    v_exp_f32 v69, v37
    v_exp_f32 v70, v38
    v_smfmac_f32_32x32x32_bf16 v[80:95], v[156:159], v[48:55], v2
    v_exp_f32 v71, v39
    v_exp_f32 v72, v40
    v_exp_f32 v73, v41
    v_smfmac_f32_32x32x32_bf16 v[80:95], v[160:163], v[56:63], v2
    buffer_load_dwordx4 v[192:195], v203, s[68:71], s38 offen
    s_add_u32 s38, s38, 7168
    v_exp_f32 v74, v42
    v_exp_f32 v75, v43
    v_exp_f32 v76, v44
    v_smfmac_f32_16x16x64_bf16 v[112:115], v[250:253], v[48:55], v2
    v_exp_f32 v77, v45
    v_smfmac_f32_16x16x64_bf16 v[112:115], v[250:253], v[56:63], v2
    s_setprio 0
    v_exp_f32 v78, v46
    v_exp_f32 v79, v47
    v_mfma_f32_32x32x16_bf16 v[32:47], v[140:143], v[132:135], 0
    ds_read_b128 v[148:151], v3 offset:12288
    ds_read_b128 v[152:155], v3 offset:13312
    v_exp_f32 v48, v16
    v_exp_f32 v49, v17
    v_exp_f32 v50, v18
    v_mfma_f32_32x32x16_bf16 v[32:47], v[144:147], v[136:139], v[32:47]
    ds_read_b128 v[164:167], v3 offset:14336
    ds_read_b128 v[168:171], v3 offset:15360
    v_exp_f32 v51, v19
    v_exp_f32 v52, v20
    v_exp_f32 v53, v21
    v_exp_f32 v54, v22
    v_smfmac_f32_32x32x32_bf16 v[96:111], v[156:159], v[64:71], v2
    v_exp_f32 v55, v23
    v_exp_f32 v56, v24
    v_exp_f32 v57, v25
    v_smfmac_f32_32x32x32_bf16 v[96:111], v[160:163], v[72:79], v2
    v_exp_f32 v58, v26
    v_exp_f32 v59, v27
    v_exp_f32 v60, v28
    v_smfmac_f32_16x16x64_bf16 v[116:119], v[250:253], v[64:71], v2
    v_exp_f32 v61, v29
    v_smfmac_f32_16x16x64_bf16 v[116:119], v[250:253], v[72:79], v2
    v_exp_f32 v62, v30
    v_exp_f32 v63, v31
    s_waitcnt lgkmcnt(0)
    v_mfma_f32_32x32x16_bf16 v[16:31], v[148:151], v[124:127], 0
    v_exp_f32 v64, v32
    v_exp_f32 v65, v33
    v_exp_f32 v66, v34
    v_mfma_f32_32x32x16_bf16 v[16:31], v[152:155], v[128:131], v[16:31]
    v_exp_f32 v67, v35
    v_exp_f32 v68, v36
    v_exp_f32 v69, v37
    v_exp_f32 v70, v38
    v_smfmac_f32_32x32x32_bf16 v[80:95], v[164:167], v[48:55], v2
    v_exp_f32 v71, v39
    v_exp_f32 v72, v40
    v_exp_f32 v73, v41
    v_smfmac_f32_32x32x32_bf16 v[80:95], v[168:171], v[56:63], v2
    v_exp_f32 v74, v42
    v_exp_f32 v75, v43
    v_exp_f32 v76, v44
    v_smfmac_f32_16x16x64_bf16 v[112:115], v[250:253], v[48:55], v2
    v_exp_f32 v77, v45
    v_smfmac_f32_16x16x64_bf16 v[112:115], v[250:253], v[56:63], v2
    s_waitcnt vmcnt(5)
    s_barrier
    s_setprio 3
    v_exp_f32 v78, v46
    v_exp_f32 v79, v47
    v_mfma_f32_32x32x16_bf16 v[32:47], v[148:151], v[132:135], 0
    ds_read_b128 v[140:143], v7 offset:32768
    ds_read_b128 v[144:147], v7 offset:33792
    v_exp_f32 v48, v16
    v_exp_f32 v49, v17
    v_exp_f32 v50, v18
    v_mfma_f32_32x32x16_bf16 v[32:47], v[152:155], v[136:139], v[32:47]
    ds_read_b128 v[156:159], v7 offset:34816
    ds_read_b128 v[160:163], v7 offset:35840
    v_exp_f32 v51, v19
    v_exp_f32 v52, v20
    v_exp_f32 v53, v21
    v_exp_f32 v54, v22
    v_smfmac_f32_32x32x32_bf16 v[96:111], v[164:167], v[64:71], v2
    v_exp_f32 v55, v23
    v_exp_f32 v56, v24
    v_exp_f32 v57, v25
    v_smfmac_f32_32x32x32_bf16 v[96:111], v[168:171], v[72:79], v2
    s_add_u32 m0, s37, 0
    s_add_u32 s12, s37, 229376
    buffer_load_dwordx4 v4, s[60:63], s12 offen offset:0 sc1 lds
    v_exp_f32 v58, v26
    v_exp_f32 v59, v27
    v_exp_f32 v60, v28
    v_smfmac_f32_16x16x64_bf16 v[116:119], v[250:253], v[64:71], v2
    v_exp_f32 v61, v29
    v_smfmac_f32_16x16x64_bf16 v[116:119], v[250:253], v[72:79], v2
    buffer_load_dwordx4 v4, s[60:63], s12 offen offset:1024 sc1 lds
    v_exp_f32 v62, v30
    v_exp_f32 v63, v31
    s_waitcnt lgkmcnt(0)
    v_mfma_f32_32x32x16_bf16 v[16:31], v[140:143], v[124:127], 0
    v_exp_f32 v64, v32
    v_exp_f32 v65, v33
    v_exp_f32 v66, v34
    v_mfma_f32_32x32x16_bf16 v[16:31], v[144:147], v[128:131], v[16:31]
    v_exp_f32 v67, v35
    v_exp_f32 v68, v36
    v_exp_f32 v69, v37
    v_exp_f32 v70, v38
    v_smfmac_f32_32x32x32_bf16 v[80:95], v[156:159], v[48:55], v2
    v_exp_f32 v71, v39
    v_exp_f32 v72, v40
    v_exp_f32 v73, v41
    v_smfmac_f32_32x32x32_bf16 v[80:95], v[160:163], v[56:63], v2
    buffer_load_dwordx4 v4, s[60:63], s12 offen offset:2048 sc1 lds
    v_exp_f32 v74, v42
    v_exp_f32 v75, v43
    v_exp_f32 v76, v44
    v_smfmac_f32_16x16x64_bf16 v[112:115], v[250:253], v[48:55], v2
    v_exp_f32 v77, v45
    v_smfmac_f32_16x16x64_bf16 v[112:115], v[250:253], v[56:63], v2
    buffer_load_dwordx4 v4, s[60:63], s12 offen offset:3072 sc1 lds
    v_exp_f32 v78, v46
    v_exp_f32 v79, v47
    v_mfma_f32_32x32x16_bf16 v[32:47], v[140:143], v[132:135], 0
    ds_read_b128 v[148:151], v7 offset:36864
    ds_read_b128 v[152:155], v7 offset:37888
    v_exp_f32 v48, v16
    v_exp_f32 v49, v17
    v_exp_f32 v50, v18
    v_mfma_f32_32x32x16_bf16 v[32:47], v[144:147], v[136:139], v[32:47]
    ds_read_b128 v[164:167], v7 offset:38912
    ds_read_b128 v[168:171], v7 offset:39936
    v_exp_f32 v51, v19
    v_exp_f32 v52, v20
    v_exp_f32 v53, v21
    v_exp_f32 v54, v22
    v_smfmac_f32_32x32x32_bf16 v[96:111], v[156:159], v[64:71], v2
    v_exp_f32 v55, v23
    v_exp_f32 v56, v24
    v_exp_f32 v57, v25
    v_smfmac_f32_32x32x32_bf16 v[96:111], v[160:163], v[72:79], v2
    buffer_load_dwordx2 v[230:231], v240, s[76:79], s92 offen offset:32
    v_exp_f32 v58, v26
    v_exp_f32 v59, v27
    v_exp_f32 v60, v28
    v_smfmac_f32_16x16x64_bf16 v[116:119], v[250:253], v[64:71], v2
    v_exp_f32 v61, v29
    v_smfmac_f32_16x16x64_bf16 v[116:119], v[250:253], v[72:79], v2
    buffer_load_dwordx2 v[232:233], v240, s[76:79], s92 offen offset:64
    v_exp_f32 v62, v30
    v_exp_f32 v63, v31
    s_waitcnt lgkmcnt(0)
    v_mfma_f32_32x32x16_bf16 v[16:31], v[148:151], v[124:127], 0
    v_exp_f32 v64, v32
    v_exp_f32 v65, v33
    v_exp_f32 v66, v34
    v_mfma_f32_32x32x16_bf16 v[16:31], v[152:155], v[128:131], v[16:31]
    v_exp_f32 v67, v35
    v_exp_f32 v68, v36
    v_exp_f32 v69, v37
    v_exp_f32 v70, v38
    v_smfmac_f32_32x32x32_bf16 v[80:95], v[164:167], v[48:55], v2
    v_exp_f32 v71, v39
    v_exp_f32 v72, v40
    v_exp_f32 v73, v41
    v_smfmac_f32_32x32x32_bf16 v[80:95], v[168:171], v[56:63], v2
    buffer_load_dwordx4 v[196:199], v203, s[68:71], s38 offen
    s_add_u32 s38, s38, 7168
    v_exp_f32 v74, v42
    v_exp_f32 v75, v43
    v_exp_f32 v76, v44
    v_smfmac_f32_16x16x64_bf16 v[112:115], v[250:253], v[48:55], v2
    v_exp_f32 v77, v45
    v_smfmac_f32_16x16x64_bf16 v[112:115], v[250:253], v[56:63], v2
    v_exp_f32 v78, v46
    v_exp_f32 v79, v47
    v_mfma_f32_32x32x16_bf16 v[32:47], v[148:151], v[132:135], 0
    ds_read_b128 v[140:143], v7 offset:40960
    ds_read_b128 v[144:147], v7 offset:41984
    v_exp_f32 v48, v16
    v_exp_f32 v49, v17
    v_exp_f32 v50, v18
    v_mfma_f32_32x32x16_bf16 v[32:47], v[152:155], v[136:139], v[32:47]
    ds_read_b128 v[156:159], v7 offset:43008
    ds_read_b128 v[160:163], v7 offset:44032
    v_exp_f32 v51, v19
    v_exp_f32 v52, v20
    v_exp_f32 v53, v21
    v_exp_f32 v54, v22
    v_smfmac_f32_32x32x32_bf16 v[96:111], v[164:167], v[64:71], v2
    v_exp_f32 v55, v23
    v_exp_f32 v56, v24
    v_exp_f32 v57, v25
    v_smfmac_f32_32x32x32_bf16 v[96:111], v[168:171], v[72:79], v2
    v_exp_f32 v58, v26
    v_exp_f32 v59, v27
    v_exp_f32 v60, v28
    v_smfmac_f32_16x16x64_bf16 v[116:119], v[250:253], v[64:71], v2
    v_exp_f32 v61, v29
    v_smfmac_f32_16x16x64_bf16 v[116:119], v[250:253], v[72:79], v2
    v_exp_f32 v62, v30
    v_exp_f32 v63, v31
    s_waitcnt lgkmcnt(0)
    v_mfma_f32_32x32x16_bf16 v[16:31], v[140:143], v[124:127], 0
    v_exp_f32 v64, v32
    v_exp_f32 v65, v33
    v_exp_f32 v66, v34
    v_mfma_f32_32x32x16_bf16 v[16:31], v[144:147], v[128:131], v[16:31]
    v_exp_f32 v67, v35
    v_exp_f32 v68, v36
    v_exp_f32 v69, v37
    v_exp_f32 v70, v38
    v_smfmac_f32_32x32x32_bf16 v[80:95], v[156:159], v[48:55], v2
    v_exp_f32 v71, v39
    v_exp_f32 v72, v40
    v_exp_f32 v73, v41
    v_smfmac_f32_32x32x32_bf16 v[80:95], v[160:163], v[56:63], v2
    v_exp_f32 v74, v42
    v_exp_f32 v75, v43
    v_exp_f32 v76, v44
    v_smfmac_f32_16x16x64_bf16 v[112:115], v[250:253], v[48:55], v2
    v_exp_f32 v77, v45
    v_smfmac_f32_16x16x64_bf16 v[112:115], v[250:253], v[56:63], v2
    v_exp_f32 v78, v46
    v_exp_f32 v79, v47
    v_mfma_f32_32x32x16_bf16 v[32:47], v[140:143], v[132:135], 0
    ds_read_b128 v[148:151], v7 offset:45056
    ds_read_b128 v[152:155], v7 offset:46080
    v_exp_f32 v48, v16
    v_exp_f32 v49, v17
    v_exp_f32 v50, v18
    v_mfma_f32_32x32x16_bf16 v[32:47], v[144:147], v[136:139], v[32:47]
    ds_read_b128 v[164:167], v7 offset:47104
    ds_read_b128 v[168:171], v7 offset:48128
    v_exp_f32 v51, v19
    v_exp_f32 v52, v20
    v_exp_f32 v53, v21
    v_exp_f32 v54, v22
    v_smfmac_f32_32x32x32_bf16 v[96:111], v[156:159], v[64:71], v2
    v_exp_f32 v55, v23
    v_exp_f32 v56, v24
    v_exp_f32 v57, v25
    v_smfmac_f32_32x32x32_bf16 v[96:111], v[160:163], v[72:79], v2
    s_add_u32 m0, s37, 98304
    s_add_u32 s12, s90, 1048576
    buffer_load_dwordx4 v236, s[56:59], s12 offen offset:0 lds
    v_exp_f32 v58, v26
    v_exp_f32 v59, v27
    v_exp_f32 v60, v28
    v_smfmac_f32_16x16x64_bf16 v[116:119], v[250:253], v[64:71], v2
    v_exp_f32 v61, v29
    v_smfmac_f32_16x16x64_bf16 v[116:119], v[250:253], v[72:79], v2
    buffer_load_dwordx2 v[234:235], v240, s[76:79], s92 offen offset:96
    v_exp_f32 v62, v30
    v_exp_f32 v63, v31
    s_waitcnt lgkmcnt(0)
    v_mfma_f32_32x32x16_bf16 v[16:31], v[148:151], v[124:127], 0
    v_exp_f32 v64, v32
    v_exp_f32 v65, v33
    v_exp_f32 v66, v34
    v_mfma_f32_32x32x16_bf16 v[16:31], v[152:155], v[128:131], v[16:31]
    v_exp_f32 v67, v35
    v_exp_f32 v68, v36
    v_exp_f32 v69, v37
    v_exp_f32 v70, v38
    v_smfmac_f32_32x32x32_bf16 v[80:95], v[164:167], v[48:55], v2
    v_exp_f32 v71, v39
    v_exp_f32 v72, v40
    v_exp_f32 v73, v41
    v_smfmac_f32_32x32x32_bf16 v[80:95], v[168:171], v[56:63], v2
    buffer_load_dwordx4 v237, s[56:59], s12 offen offset:1024 lds
    v_exp_f32 v74, v42
    v_exp_f32 v75, v43
    v_exp_f32 v76, v44
    v_smfmac_f32_16x16x64_bf16 v[112:115], v[250:253], v[48:55], v2
    v_exp_f32 v77, v45
    v_smfmac_f32_16x16x64_bf16 v[112:115], v[250:253], v[56:63], v2
    s_setprio 2
    v_exp_f32 v78, v46
    v_exp_f32 v79, v47
    v_mfma_f32_32x32x16_bf16 v[32:47], v[148:151], v[132:135], 0
    ds_read_b128 v[140:143], v244 offset:0
    ds_read_b128 v[144:147], v244 offset:1024
    v_exp_f32 v48, v16
    v_exp_f32 v49, v17
    v_exp_f32 v50, v18
    v_mfma_f32_32x32x16_bf16 v[32:47], v[152:155], v[136:139], v[32:47]
    ds_read_b128 v[156:159], v244 offset:2048
    ds_read_b128 v[160:163], v244 offset:3072
    v_exp_f32 v51, v19
    v_exp_f32 v52, v20
    v_exp_f32 v53, v21
    v_exp_f32 v54, v22
    v_smfmac_f32_32x32x32_bf16 v[96:111], v[164:167], v[64:71], v2
    v_exp_f32 v55, v23
    v_exp_f32 v56, v24
    v_exp_f32 v57, v25
    v_smfmac_f32_32x32x32_bf16 v[96:111], v[168:171], v[72:79], v2
    buffer_load_dwordx4 v238, s[56:59], s12 offen offset:2048 lds
    v_exp_f32 v58, v26
    v_exp_f32 v59, v27
    v_exp_f32 v60, v28
    v_smfmac_f32_16x16x64_bf16 v[116:119], v[250:253], v[64:71], v2
    v_exp_f32 v61, v29
    v_smfmac_f32_16x16x64_bf16 v[116:119], v[250:253], v[72:79], v2
    v_exp_f32 v62, v30
    v_exp_f32 v63, v31
    s_waitcnt lgkmcnt(0)
    v_mfma_f32_32x32x16_bf16 v[16:31], v[140:143], v[124:127], 0
    v_exp_f32 v64, v32
    v_exp_f32 v65, v33
    v_exp_f32 v66, v34
    v_mfma_f32_32x32x16_bf16 v[16:31], v[144:147], v[128:131], v[16:31]
    v_exp_f32 v67, v35
    v_exp_f32 v68, v36
    v_exp_f32 v69, v37
    v_exp_f32 v70, v38
    v_smfmac_f32_32x32x32_bf16 v[80:95], v[156:159], v[48:55], v2
    v_exp_f32 v71, v39
    v_exp_f32 v72, v40
    v_exp_f32 v73, v41
    v_smfmac_f32_32x32x32_bf16 v[80:95], v[160:163], v[56:63], v2
    buffer_load_dwordx4 v239, s[56:59], s12 offen offset:3072 lds
    v_exp_f32 v74, v42
    v_exp_f32 v75, v43
    v_exp_f32 v76, v44
    v_smfmac_f32_16x16x64_bf16 v[112:115], v[250:253], v[48:55], v2
    v_exp_f32 v77, v45
    v_smfmac_f32_16x16x64_bf16 v[112:115], v[250:253], v[56:63], v2
    v_exp_f32 v78, v46
    v_exp_f32 v79, v47
    v_mfma_f32_32x32x16_bf16 v[32:47], v[140:143], v[132:135], 0
    ds_read_b128 v[148:151], v244 offset:4096
    ds_read_b128 v[152:155], v244 offset:5120
    v_exp_f32 v48, v16
    v_exp_f32 v49, v17
    v_exp_f32 v50, v18
    v_mfma_f32_32x32x16_bf16 v[32:47], v[144:147], v[136:139], v[32:47]
    ds_read_b128 v[164:167], v244 offset:6144
    ds_read_b128 v[168:171], v244 offset:7168
    v_exp_f32 v51, v19
    v_exp_f32 v52, v20
    v_exp_f32 v53, v21
    v_exp_f32 v54, v22
    v_smfmac_f32_32x32x32_bf16 v[96:111], v[156:159], v[64:71], v2
    v_exp_f32 v55, v23
    v_exp_f32 v56, v24
    v_exp_f32 v57, v25
    v_smfmac_f32_32x32x32_bf16 v[96:111], v[160:163], v[72:79], v2
    buffer_load_dwordx4 v[200:203], v203, s[68:71], s38 offen
    s_add_u32 s38, s38, 7168
    v_exp_f32 v58, v26
    v_exp_f32 v59, v27
    v_exp_f32 v60, v28
    v_smfmac_f32_16x16x64_bf16 v[116:119], v[250:253], v[64:71], v2
    v_exp_f32 v61, v29
    v_smfmac_f32_16x16x64_bf16 v[116:119], v[250:253], v[72:79], v2
    v_exp_f32 v62, v30
    v_exp_f32 v63, v31
    s_waitcnt lgkmcnt(0)
    v_mfma_f32_32x32x16_bf16 v[16:31], v[148:151], v[124:127], 0
    v_exp_f32 v64, v32
    v_exp_f32 v65, v33
    v_exp_f32 v66, v34
    v_mfma_f32_32x32x16_bf16 v[16:31], v[152:155], v[128:131], v[16:31]
    v_exp_f32 v67, v35
    v_exp_f32 v68, v36
    v_exp_f32 v69, v37
    v_exp_f32 v70, v38
    v_smfmac_f32_32x32x32_bf16 v[80:95], v[164:167], v[48:55], v2
    v_exp_f32 v71, v39
    v_exp_f32 v72, v40
    v_exp_f32 v73, v41
    v_smfmac_f32_32x32x32_bf16 v[80:95], v[168:171], v[56:63], v2
    v_exp_f32 v74, v42
    v_exp_f32 v75, v43
    v_exp_f32 v76, v44
    v_smfmac_f32_16x16x64_bf16 v[112:115], v[250:253], v[48:55], v2
    v_exp_f32 v77, v45
    v_smfmac_f32_16x16x64_bf16 v[112:115], v[250:253], v[56:63], v2
    s_setprio 1
    v_exp_f32 v78, v46
    v_exp_f32 v79, v47
    v_mfma_f32_32x32x16_bf16 v[32:47], v[148:151], v[132:135], 0
    ds_read_b128 v[140:143], v244 offset:8192
    ds_read_b128 v[144:147], v244 offset:9216
    v_exp_f32 v48, v16
    v_exp_f32 v49, v17
    v_exp_f32 v50, v18
    v_mfma_f32_32x32x16_bf16 v[32:47], v[152:155], v[136:139], v[32:47]
    ds_read_b128 v[156:159], v244 offset:10240
    ds_read_b128 v[160:163], v244 offset:11264
    v_exp_f32 v51, v19
    v_exp_f32 v52, v20
    v_exp_f32 v53, v21
    v_exp_f32 v54, v22
    v_smfmac_f32_32x32x32_bf16 v[96:111], v[164:167], v[64:71], v2
    v_exp_f32 v55, v23
    v_exp_f32 v56, v24
    v_exp_f32 v57, v25
    v_smfmac_f32_32x32x32_bf16 v[96:111], v[168:171], v[72:79], v2
    v_exp_f32 v58, v26
    v_exp_f32 v59, v27
    v_exp_f32 v60, v28
    v_smfmac_f32_16x16x64_bf16 v[116:119], v[250:253], v[64:71], v2
    v_exp_f32 v61, v29
    v_smfmac_f32_16x16x64_bf16 v[116:119], v[250:253], v[72:79], v2
    v_exp_f32 v62, v30
    v_exp_f32 v63, v31
    s_waitcnt lgkmcnt(0)
    v_mfma_f32_32x32x16_bf16 v[16:31], v[140:143], v[124:127], 0
    v_exp_f32 v64, v32
    v_exp_f32 v65, v33
    v_exp_f32 v66, v34
    v_mfma_f32_32x32x16_bf16 v[16:31], v[144:147], v[128:131], v[16:31]
    v_exp_f32 v67, v35
    v_exp_f32 v68, v36
    v_exp_f32 v69, v37
    v_exp_f32 v70, v38
    v_smfmac_f32_32x32x32_bf16 v[80:95], v[156:159], v[48:55], v2
    v_exp_f32 v71, v39
    v_exp_f32 v72, v40
    v_exp_f32 v73, v41
    v_smfmac_f32_32x32x32_bf16 v[80:95], v[160:163], v[56:63], v2
    v_exp_f32 v74, v42
    v_exp_f32 v75, v43
    v_exp_f32 v76, v44
    v_smfmac_f32_16x16x64_bf16 v[112:115], v[250:253], v[48:55], v2
    v_exp_f32 v77, v45
    v_smfmac_f32_16x16x64_bf16 v[112:115], v[250:253], v[56:63], v2
    s_setprio 0
    v_exp_f32 v78, v46
    v_exp_f32 v79, v47
    v_mfma_f32_32x32x16_bf16 v[32:47], v[140:143], v[132:135], 0
    ds_read_b128 v[148:151], v244 offset:12288
    ds_read_b128 v[152:155], v244 offset:13312
    v_exp_f32 v48, v16
    v_exp_f32 v49, v17
    v_exp_f32 v50, v18
    v_mfma_f32_32x32x16_bf16 v[32:47], v[144:147], v[136:139], v[32:47]
    ds_read_b128 v[164:167], v244 offset:14336
    ds_read_b128 v[168:171], v244 offset:15360
    v_exp_f32 v51, v19
    v_exp_f32 v52, v20
    v_exp_f32 v53, v21
    v_exp_f32 v54, v22
    v_smfmac_f32_32x32x32_bf16 v[96:111], v[156:159], v[64:71], v2
    v_exp_f32 v55, v23
    v_exp_f32 v56, v24
    v_exp_f32 v57, v25
    v_smfmac_f32_32x32x32_bf16 v[96:111], v[160:163], v[72:79], v2
    buffer_load_dword v243, v6, s[60:63], 0 offen sc1
    v_exp_f32 v58, v26
    v_exp_f32 v59, v27
    v_exp_f32 v60, v28
    v_smfmac_f32_16x16x64_bf16 v[116:119], v[250:253], v[64:71], v2
    v_exp_f32 v61, v29
    v_smfmac_f32_16x16x64_bf16 v[116:119], v[250:253], v[72:79], v2
    v_exp_f32 v62, v30
    v_exp_f32 v63, v31
    s_waitcnt lgkmcnt(0)
    v_mfma_f32_32x32x16_bf16 v[16:31], v[148:151], v[124:127], 0
    v_exp_f32 v64, v32
    v_exp_f32 v65, v33
    v_exp_f32 v66, v34
    v_mfma_f32_32x32x16_bf16 v[16:31], v[152:155], v[128:131], v[16:31]
    v_exp_f32 v67, v35
    v_exp_f32 v68, v36
    v_exp_f32 v69, v37
    v_exp_f32 v70, v38
    v_smfmac_f32_32x32x32_bf16 v[80:95], v[164:167], v[48:55], v2
    v_exp_f32 v71, v39
    v_exp_f32 v72, v40
    v_exp_f32 v73, v41
    v_smfmac_f32_32x32x32_bf16 v[80:95], v[168:171], v[56:63], v2
    buffer_load_dword v245, v245, s[60:63], 0 offen sc1
    v_exp_f32 v74, v42
    v_exp_f32 v75, v43
    v_exp_f32 v76, v44
    v_smfmac_f32_16x16x64_bf16 v[112:115], v[250:253], v[48:55], v2
    v_exp_f32 v77, v45
    v_smfmac_f32_16x16x64_bf16 v[112:115], v[250:253], v[56:63], v2
    s_waitcnt vmcnt(11)
    s_barrier
    s_setprio 3
    v_exp_f32 v78, v46
    v_exp_f32 v79, v47
    v_mfma_f32_32x32x16_bf16 v[32:47], v[148:151], v[132:135], 0
    ds_read_b128 v[140:143], v3 offset:0
    ds_read_b128 v[144:147], v3 offset:1024
    v_exp_f32 v48, v16
    v_exp_f32 v49, v17
    v_exp_f32 v50, v18
    v_mfma_f32_32x32x16_bf16 v[32:47], v[152:155], v[136:139], v[32:47]
    ds_read_b128 v[156:159], v3 offset:2048
    ds_read_b128 v[160:163], v3 offset:3072
    v_exp_f32 v51, v19
    v_exp_f32 v52, v20
    v_exp_f32 v53, v21
    v_exp_f32 v54, v22
    v_smfmac_f32_32x32x32_bf16 v[96:111], v[164:167], v[64:71], v2
    v_exp_f32 v55, v23
    v_exp_f32 v56, v24
    v_exp_f32 v57, v25
    v_smfmac_f32_32x32x32_bf16 v[96:111], v[168:171], v[72:79], v2
    s_add_u32 m0, s37, 131072
    s_add_u32 s12, s90, 1572864
    buffer_load_dwordx4 v236, s[56:59], s12 offen offset:0 lds
    v_exp_f32 v58, v26
    v_exp_f32 v59, v27
    v_exp_f32 v60, v28
    v_smfmac_f32_16x16x64_bf16 v[116:119], v[250:253], v[64:71], v2
    v_exp_f32 v61, v29
    v_smfmac_f32_16x16x64_bf16 v[116:119], v[250:253], v[72:79], v2
    buffer_load_dwordx4 v237, s[56:59], s12 offen offset:1024 lds
    v_exp_f32 v62, v30
    v_exp_f32 v63, v31
    s_waitcnt lgkmcnt(0)
    v_mfma_f32_32x32x16_bf16 v[16:31], v[140:143], v[124:127], 0
    v_exp_f32 v64, v32
    v_exp_f32 v65, v33
    v_exp_f32 v66, v34
    v_mfma_f32_32x32x16_bf16 v[16:31], v[144:147], v[128:131], v[16:31]
    v_exp_f32 v67, v35
    v_exp_f32 v68, v36
    v_exp_f32 v69, v37
    v_exp_f32 v70, v38
    v_smfmac_f32_32x32x32_bf16 v[80:95], v[156:159], v[48:55], v2
    v_exp_f32 v71, v39
    v_exp_f32 v72, v40
    v_exp_f32 v73, v41
    v_smfmac_f32_32x32x32_bf16 v[80:95], v[160:163], v[56:63], v2
    buffer_load_dwordx4 v238, s[56:59], s12 offen offset:2048 lds
    v_exp_f32 v74, v42
    v_exp_f32 v75, v43
    v_exp_f32 v76, v44
    v_smfmac_f32_16x16x64_bf16 v[112:115], v[250:253], v[48:55], v2
    v_exp_f32 v77, v45
    v_smfmac_f32_16x16x64_bf16 v[112:115], v[250:253], v[56:63], v2
    buffer_load_dwordx4 v239, s[56:59], s12 offen offset:3072 lds
    v_exp_f32 v78, v46
    v_exp_f32 v79, v47
    v_mfma_f32_32x32x16_bf16 v[32:47], v[140:143], v[132:135], 0
    ds_read_b128 v[148:151], v3 offset:4096
    ds_read_b128 v[152:155], v3 offset:5120
    v_exp_f32 v48, v16
    v_exp_f32 v49, v17
    v_exp_f32 v50, v18
    v_mfma_f32_32x32x16_bf16 v[32:47], v[144:147], v[136:139], v[32:47]
    ds_read_b128 v[164:167], v3 offset:6144
    ds_read_b128 v[168:171], v3 offset:7168
    v_exp_f32 v51, v19
    v_exp_f32 v52, v20
    v_exp_f32 v53, v21
    v_exp_f32 v54, v22
    v_smfmac_f32_32x32x32_bf16 v[96:111], v[156:159], v[64:71], v2
    v_exp_f32 v55, v23
    v_exp_f32 v56, v24
    v_exp_f32 v57, v25
    v_smfmac_f32_32x32x32_bf16 v[96:111], v[160:163], v[72:79], v2
    s_add_u32 m0, s37, 65536
    s_add_u32 s12, s90, 524288
    buffer_load_dwordx4 v236, s[56:59], s12 offen offset:0 lds
    v_exp_f32 v58, v26
    v_exp_f32 v59, v27
    v_exp_f32 v60, v28
    v_smfmac_f32_16x16x64_bf16 v[116:119], v[250:253], v[64:71], v2
    v_exp_f32 v61, v29
    v_smfmac_f32_16x16x64_bf16 v[116:119], v[250:253], v[72:79], v2
    v_exp_f32 v62, v30
    v_exp_f32 v63, v31
    s_waitcnt lgkmcnt(0)
    v_mfma_f32_32x32x16_bf16 v[16:31], v[148:151], v[124:127], 0
    v_exp_f32 v64, v32
    v_exp_f32 v65, v33
    v_exp_f32 v66, v34
    v_mfma_f32_32x32x16_bf16 v[16:31], v[152:155], v[128:131], v[16:31]
    v_exp_f32 v67, v35
    v_exp_f32 v68, v36
    v_exp_f32 v69, v37
    v_exp_f32 v70, v38
    v_smfmac_f32_32x32x32_bf16 v[80:95], v[164:167], v[48:55], v2
    v_exp_f32 v71, v39
    v_exp_f32 v72, v40
    v_exp_f32 v73, v41
    v_smfmac_f32_32x32x32_bf16 v[80:95], v[168:171], v[56:63], v2
    buffer_load_dwordx4 v237, s[56:59], s12 offen offset:1024 lds
    v_exp_f32 v74, v42
    v_exp_f32 v75, v43
    v_exp_f32 v76, v44
    v_smfmac_f32_16x16x64_bf16 v[112:115], v[250:253], v[48:55], v2
    v_exp_f32 v77, v45
    v_smfmac_f32_16x16x64_bf16 v[112:115], v[250:253], v[56:63], v2
    s_setprio 2
    buffer_load_dwordx4 v238, s[56:59], s12 offen offset:2048 lds
    v_exp_f32 v78, v46
    v_exp_f32 v79, v47
    v_mfma_f32_32x32x16_bf16 v[32:47], v[148:151], v[132:135], 0
    ds_read_b128 v[140:143], v3 offset:8192
    ds_read_b128 v[144:147], v3 offset:9216
    v_exp_f32 v48, v16
    v_exp_f32 v49, v17
    v_exp_f32 v50, v18
    v_mfma_f32_32x32x16_bf16 v[32:47], v[152:155], v[136:139], v[32:47]
    ds_read_b128 v[156:159], v3 offset:10240
    ds_read_b128 v[160:163], v3 offset:11264
    v_exp_f32 v51, v19
    v_exp_f32 v52, v20
    v_exp_f32 v53, v21
    v_exp_f32 v54, v22
    v_smfmac_f32_32x32x32_bf16 v[96:111], v[164:167], v[64:71], v2
    v_exp_f32 v55, v23
    v_exp_f32 v56, v24
    v_exp_f32 v57, v25
    v_smfmac_f32_32x32x32_bf16 v[96:111], v[168:171], v[72:79], v2
    buffer_load_dwordx4 v239, s[56:59], s12 offen offset:3072 lds
    v_exp_f32 v58, v26
    v_exp_f32 v59, v27
    v_exp_f32 v60, v28
    v_smfmac_f32_16x16x64_bf16 v[116:119], v[250:253], v[64:71], v2
    v_exp_f32 v61, v29
    v_smfmac_f32_16x16x64_bf16 v[116:119], v[250:253], v[72:79], v2
    v_exp_f32 v62, v30
    v_exp_f32 v63, v31
    s_waitcnt lgkmcnt(0)
    v_mfma_f32_32x32x16_bf16 v[16:31], v[140:143], v[124:127], 0
    v_exp_f32 v64, v32
    v_exp_f32 v65, v33
    v_exp_f32 v66, v34
    v_mfma_f32_32x32x16_bf16 v[16:31], v[144:147], v[128:131], v[16:31]
    v_exp_f32 v67, v35
    v_exp_f32 v68, v36
    v_exp_f32 v69, v37
    v_exp_f32 v70, v38
    v_smfmac_f32_32x32x32_bf16 v[80:95], v[156:159], v[48:55], v2
    v_exp_f32 v71, v39
    v_exp_f32 v72, v40
    v_exp_f32 v73, v41
    v_smfmac_f32_32x32x32_bf16 v[80:95], v[160:163], v[56:63], v2
    v_exp_f32 v74, v42
    v_exp_f32 v75, v43
    v_exp_f32 v76, v44
    v_smfmac_f32_16x16x64_bf16 v[112:115], v[250:253], v[48:55], v2
    v_exp_f32 v77, v45
    v_smfmac_f32_16x16x64_bf16 v[112:115], v[250:253], v[56:63], v2
    s_setprio 1
    v_exp_f32 v78, v46
    v_exp_f32 v79, v47
    v_mfma_f32_32x32x16_bf16 v[32:47], v[140:143], v[132:135], 0
    v_exp_f32 v48, v16
    v_exp_f32 v49, v17
    v_exp_f32 v50, v18
    v_mfma_f32_32x32x16_bf16 v[32:47], v[144:147], v[136:139], v[32:47]
    ds_read_b128 v[164:167], v3 offset:14336
    ds_read_b128 v[168:171], v3 offset:15360
    v_exp_f32 v51, v19
    v_exp_f32 v52, v20
    v_exp_f32 v53, v21
    v_exp_f32 v54, v22
    v_smfmac_f32_32x32x32_bf16 v[96:111], v[156:159], v[64:71], v2
    v_exp_f32 v55, v23
    v_exp_f32 v56, v24
    v_exp_f32 v57, v25
    v_smfmac_f32_32x32x32_bf16 v[96:111], v[160:163], v[72:79], v2
    v_readfirstlane_b32 s8, v241
    s_lshl_b32 s9, s6, 2
    s_add_u32 s9, s9, s4
    s_lshl_b32 s17, s9, 16
    s_add_u32 s17, s17, 4194304
    v_cmp_ne_u32 vcc, s8, v241
    s_lshl_b32 s10, s7, 1
    s_add_u32 s10, s10, s5
    s_lshl_b32 s11, s10, 11
    s_add_u32 s11, s11, s17
    s_cmp_eq_u64 vcc, 0
    s_cselect_b32 s25, 1, 0
    s_lshl_b32 s18, s6, 16
    s_add_u32 s18, s18, 524544
    s_lshl_b32 s10, s10, 2
    s_lshl_b32 s9, s4, 12
    s_add_u32 s15, s10, s9
    s_mov_b32 s89, s11
    v_exp_f32 v58, v26
    v_exp_f32 v59, v27
    v_exp_f32 v60, v28
    v_smfmac_f32_16x16x64_bf16 v[116:119], v[250:253], v[64:71], v2
    v_exp_f32 v61, v29
    v_smfmac_f32_16x16x64_bf16 v[116:119], v[250:253], v[72:79], v2
    s_setprio 0
    v_exp_f32 v62, v30
    v_exp_f32 v63, v31
    s_waitcnt lgkmcnt(0)
    v_smfmac_f32_32x32x32_bf16 v[80:95], v[164:167], v[48:55], v2
    s_barrier
    v_exp_f32 v64, v32
    v_exp_f32 v65, v33
    v_exp_f32 v66, v34
    v_smfmac_f32_16x16x64_bf16 v[112:115], v[250:253], v[48:55], v2
    v_exp_f32 v67, v35
    v_smfmac_f32_16x16x64_bf16 v[112:115], v[250:253], v[56:63], v2
    v_exp_f32 v68, v36
    v_smfmac_f32_32x32x32_bf16 v[80:95], v[168:171], v[56:63], v2
    v_exp_f32 v69, v37
    v_exp_f32 v70, v38
    v_exp_f32 v71, v39
    v_exp_f32 v72, v40
    v_exp_f32 v73, v41
    v_smfmac_f32_32x32x32_bf16 v[96:111], v[164:167], v[64:71], v2
    v_exp_f32 v74, v42
    v_exp_f32 v75, v43
    v_exp_f32 v76, v44
    v_smfmac_f32_16x16x64_bf16 v[116:119], v[250:253], v[64:71], v2
    v_exp_f32 v77, v45
    v_exp_f32 v78, v46
    v_exp_f32 v79, v47
    s_mov_b32 s8, 0x07060501
    s_mov_b32 s9, 0x07060502
    s_mov_b32 s10, 0x07060503
    v_add_u32 v14, s37, v4
    v_smfmac_f32_32x32x32_bf16 v[96:111], v[168:171], v[72:79], v2
    v_perm_b32 v80, v80, v112, s8
    v_perm_b32 v81, v81, v112, s9
    v_perm_b32 v82, v82, v112, s10
    v_smfmac_f32_16x16x64_bf16 v[116:119], v[250:253], v[72:79], v2
    ds_write_b128 v14, v[80:83] offset:0
    ds_write_b128 v14, v[84:87] offset:1024
    ds_write_b128 v14, v[88:91] offset:2048
    ds_write_b128 v14, v[92:95] offset:3072
    v_xor_b32 v14, 0x4000, v14
    s_setprio 0
    s_waitcnt lgkmcnt(0)
    s_barrier
    ds_read_b128 v[80:83], v14 offset:0
    ds_read_b128 v[84:87], v14 offset:1024
    ds_read_b128 v[88:91], v14 offset:2048
    ds_read_b128 v[92:95], v14 offset:3072
    s_mov_b32 s8, 0x0c04000c
    s_mov_b32 s9, 0x04020100
    s_waitcnt lgkmcnt(3)
    v_perm_b32 v14, v81, v80, s8
    v_perm_b32 v14, v82, v14, s9
    v_add_f32 v117, v116, v14
    v_add_f32 v116, v116, v14
    v_pk_add_f32 v[96:97], v[96:97], v[80:81]
    v_pk_add_f32 v[98:99], v[98:99], v[82:83]
    v_permlane32_swap_b32 v116, v117
    v_rcp_f32 v117, v116
    s_waitcnt lgkmcnt(2)
    v_pk_add_f32 v[100:101], v[100:101], v[84:85]
    v_pk_add_f32 v[102:103], v[102:103], v[86:87]
    s_waitcnt lgkmcnt(1)
    v_pk_add_f32 v[104:105], v[104:105], v[88:89]
    v_pk_add_f32 v[106:107], v[106:107], v[90:91]
    s_waitcnt lgkmcnt(0)
    v_pk_add_f32 v[108:109], v[108:109], v[92:93]
    v_pk_add_f32 v[110:111], v[110:111], v[94:95]
    v_pk_mul_f32 v[80:81], v[96:97], v[116:117] op_sel:[0,1] op_sel_hi:[1,1]
    v_pk_mul_f32 v[82:83], v[98:99], v[116:117] op_sel:[0,1] op_sel_hi:[1,1]
    v_pk_mul_f32 v[84:85], v[100:101], v[116:117] op_sel:[0,1] op_sel_hi:[1,1]
    v_pk_mul_f32 v[86:87], v[102:103], v[116:117] op_sel:[0,1] op_sel_hi:[1,1]
    v_cvt_pk_bf16_f32 v48, v80, v81
    v_cvt_pk_bf16_f32 v49, v82, v83
    v_cvt_pk_bf16_f32 v50, v84, v85
    v_cvt_pk_bf16_f32 v51, v86, v87
    buffer_store_dwordx4 v[48:51], v4, s[60:63], s11 offen offset:0 sc1
    v_pk_mul_f32 v[88:89], v[104:105], v[116:117] op_sel:[0,1] op_sel_hi:[1,1]
    v_pk_mul_f32 v[90:91], v[106:107], v[116:117] op_sel:[0,1] op_sel_hi:[1,1]
    v_pk_mul_f32 v[92:93], v[108:109], v[116:117] op_sel:[0,1] op_sel_hi:[1,1]
    v_pk_mul_f32 v[94:95], v[110:111], v[116:117] op_sel:[0,1] op_sel_hi:[1,1]
    v_cvt_pk_bf16_f32 v52, v88, v89
    v_cvt_pk_bf16_f32 v53, v90, v91
    v_cvt_pk_bf16_f32 v54, v92, v93
    v_cvt_pk_bf16_f32 v55, v94, v95
    buffer_store_dwordx4 v[52:55], v4, s[60:63], s11 offen offset:1024 sc1
    v_cmp_nlt_f32 vcc, 0x3a800000, v116
    v_maximum3_f32 v14, abs(v96), abs(v97), 0
    s_mov_b64 s[32:33], vcc
    v_cmp_ngt_f32 vcc, 0x5d800000, v116
    v_maximum3_f32 v14, abs(v98), abs(v99), v14
    v_maximum3_f32 v14, abs(v100), abs(v101), v14
    v_maximum3_f32 v14, abs(v102), abs(v103), v14
    v_maximum3_f32 v14, abs(v104), abs(v105), v14
    v_maximum3_f32 v14, abs(v106), abs(v107), v14
    v_maximum3_f32 v14, abs(v108), abs(v109), v14
    v_maximum3_f32 v14, abs(v110), abs(v111), v14
    s_or_b64 s[32:33], s[32:33], vcc
    v_cmp_ngt_f32 vcc, 0x7b800000, v14
    v_mov_b32 v15, s15
    s_or_b64 s[32:33], s[32:33], vcc
    s_cbranch_scc1 L_slow
L_slow_ret:
    v_and_b32 v10, 3, v1
    v_lshlrev_b32 v10, 3, v10
    v_bfe_u32 v14, v1, 2, 2
    v_lshl_add_u32 v10, v14, 7, v10
    v_and_b32 v14, 8, v1
    v_lshl_add_u32 v10, v14, 3, v10
    v_bfe_u32 v14, v1, 4, 1
    v_mul_u32_u24 v14, 544, v14
    v_add_u32 v10, v10, v14
    v_lshrrev_b32 v14, 5, v1
    v_mul_u32_u24 v14, 2048, v14
    v_add_u32 v10, v10, v14
    s_lshl_b32 s8, s5, 16
    s_add_u32 s8, s8, 32768
    v_add_u32 v10, s8, v10
    v_xor_b32 v11, 32, v10
    v_xor_b32 v12, 64, v10
    v_xor_b32 v13, 0x60, v10
    v_and_b32 v14, 0x300, v4
    s_lshl_b32 s8, s5, 8
    v_add3_u32 v8, v14, v4, s8
    v_xor_b32 v9, 256, v8
    s_lshl_b32 s8, s5, 15
    s_add_u32 s17, s17, s8
    s_mov_b32 s14, 0xffff0000
    s_mov_b32 s12, 0x05040100
    s_mov_b32 s13, 0x07060302
    s_waitcnt vmcnt(2)
    v_and_b32 v14, 15, v1
    v_lshlrev_b32 v14, 3, v14
    v_lshl_add_u32 v245, v240, 9, v14
    v_lshlrev_b32 v16, 16, v220
    v_and_b32 v17, s14, v220
    v_lshlrev_b32 v18, 16, v221
    v_and_b32 v19, s14, v221
    v_lshlrev_b32 v20, 16, v222
    v_and_b32 v21, s14, v222
    v_lshlrev_b32 v22, 16, v223
    v_and_b32 v23, s14, v223
    v_lshlrev_b32 v24, 16, v224
    v_and_b32 v25, s14, v224
    v_lshlrev_b32 v26, 16, v225
    v_and_b32 v27, s14, v225
    v_lshlrev_b32 v28, 16, v226
    v_and_b32 v29, s14, v226
    v_lshlrev_b32 v30, 16, v227
    v_and_b32 v31, s14, v227
    s_mov_b64 exec, 1
    s_cmp_eq_u32 s25, 1
    s_waitcnt vmcnt(0)
    s_cbranch_scc0 L_ofl_slow
    buffer_store_dword v15, v15, s[60:63], s18 offen
    s_branch L_ofl_done
L_ofl_slow:
    buffer_store_dword v15, v15, s[60:63], s18 offen sc1
L_ofl_done:
    s_mov_b64 exec, -1
    s_cmp_eq_u32 s3, 0
    s_cbranch_scc0 L_s2_ok
    buffer_load_dwordx2 v[64:65], v245, s[60:63], s18 offen sc1
L_s2:
    s_waitcnt vmcnt(0)
    v_max_u32 v14, v64, v65
    v_cmp_eq_u32 vcc, -1, v14
    s_nop 0
    s_cbranch_vccz L_s2_ok
    buffer_load_dwordx2 v[64:65], v245, s[60:63], s18 offen sc1
    s_add_u32 s26, s26, 1
    s_cmp_lt_u32 s26, 200000
    s_cbranch_scc1 L_s2
    s_waitcnt vmcnt(0)
L_s2_ok:
    s_barrier
    s_setprio 3
    buffer_load_dwordx4 v[104:107], v8, s[60:63], s17 offen offset:0 sc1
    buffer_load_dwordx4 v[108:111], v9, s[60:63], s17 offen offset:0 sc1
    buffer_load_dwordx4 v[112:115], v8, s[60:63], s17 offen offset:2048 sc1
    buffer_load_dwordx4 v[116:119], v9, s[60:63], s17 offen offset:2048 sc1
    s_add_u32 s17, s17, 4096
    ds_read_b64_tr_b16 v[48:49], v10 offset:0
    ds_read_b64_tr_b16 v[50:51], v10 offset:1024
    ds_read_b64_tr_b16 v[52:53], v11 offset:0
    ds_read_b64_tr_b16 v[54:55], v11 offset:1024
    ds_read_b64_tr_b16 v[56:57], v12 offset:0
    ds_read_b64_tr_b16 v[58:59], v12 offset:1024
    ds_read_b64_tr_b16 v[60:61], v13 offset:0
    ds_read_b64_tr_b16 v[62:63], v13 offset:1024
    v_lshlrev_b32 v152, 16, v228
    v_and_b32 v153, s14, v228
    v_lshlrev_b32 v154, 16, v229
    v_and_b32 v155, s14, v229
    v_lshlrev_b32 v156, 16, v230
    v_and_b32 v157, s14, v230
    v_lshlrev_b32 v158, 16, v231
    v_and_b32 v159, s14, v231
    v_lshlrev_b32 v160, 16, v232
    v_and_b32 v161, s14, v232
    v_lshlrev_b32 v162, 16, v233
    v_and_b32 v163, s14, v233
    v_lshlrev_b32 v164, 16, v234
    v_and_b32 v165, s14, v234
    v_lshlrev_b32 v166, 16, v235
    v_and_b32 v167, s14, v235
    v_pk_add_f32 v[168:169], v[152:153], v[154:155]
    v_pk_add_f32 v[168:169], v[168:169], v[156:157]
    v_pk_add_f32 v[168:169], v[168:169], v[158:159]
    v_pk_add_f32 v[168:169], v[168:169], v[160:161]
    v_pk_add_f32 v[168:169], v[168:169], v[162:163]
    v_pk_add_f32 v[168:169], v[168:169], v[164:165]
    v_pk_add_f32 v[168:169], v[168:169], v[166:167]
    v_add_f32 v168, v168, v169
    s_waitcnt vmcnt(2) lgkmcnt(4)
    v_mfma_f32_16x16x32_bf16 v[16:19], v[48:51], v[104:107], v[16:19]
    ds_read_b64_tr_b16 v[64:65], v10 offset:4096
    v_mfma_f32_16x16x32_bf16 v[32:35], v[48:51], v[108:111], 0
    ds_read_b64_tr_b16 v[66:67], v10 offset:5120
    buffer_load_dwordx4 v[120:123], v8, s[60:63], s17 offen offset:0 sc1
    v_mfma_f32_16x16x32_bf16 v[20:23], v[52:55], v[104:107], v[20:23]
    ds_read_b64_tr_b16 v[68:69], v11 offset:4096
    v_mfma_f32_16x16x32_bf16 v[36:39], v[52:55], v[108:111], 0
    ds_read_b64_tr_b16 v[70:71], v11 offset:5120
    buffer_load_dwordx4 v[124:127], v9, s[60:63], s17 offen offset:0 sc1
    s_waitcnt lgkmcnt(4)
    v_mfma_f32_16x16x32_bf16 v[24:27], v[56:59], v[104:107], v[24:27]
    ds_read_b64_tr_b16 v[72:73], v12 offset:4096
    v_mfma_f32_16x16x32_bf16 v[40:43], v[56:59], v[108:111], 0
    ds_read_b64_tr_b16 v[74:75], v12 offset:5120
    buffer_load_dwordx4 v[128:131], v8, s[60:63], s17 offen offset:2048 sc1
    v_mfma_f32_16x16x32_bf16 v[28:31], v[60:63], v[104:107], v[28:31]
    ds_read_b64_tr_b16 v[76:77], v13 offset:4096
    v_mfma_f32_16x16x32_bf16 v[44:47], v[60:63], v[108:111], 0
    ds_read_b64_tr_b16 v[78:79], v13 offset:5120
    s_waitcnt vmcnt(3) lgkmcnt(4)
    v_mfma_f32_16x16x32_bf16 v[16:19], v[64:67], v[112:115], v[16:19]
    ds_read_b64_tr_b16 v[48:49], v10 offset:8192
    v_mfma_f32_16x16x32_bf16 v[32:35], v[64:67], v[116:119], v[32:35]
    ds_read_b64_tr_b16 v[50:51], v10 offset:9216
    buffer_load_dwordx4 v[132:135], v9, s[60:63], s17 offen offset:2048 sc1
    s_add_u32 s17, s17, 4096
    v_mfma_f32_16x16x32_bf16 v[20:23], v[68:71], v[112:115], v[20:23]
    ds_read_b64_tr_b16 v[52:53], v11 offset:8192
    v_mfma_f32_16x16x32_bf16 v[36:39], v[68:71], v[116:119], v[36:39]
    ds_read_b64_tr_b16 v[54:55], v11 offset:9216
    buffer_load_dwordx4 v[136:139], v8, s[60:63], s17 offen offset:0 sc1
    s_waitcnt lgkmcnt(4)
    v_mfma_f32_16x16x32_bf16 v[24:27], v[72:75], v[112:115], v[24:27]
    ds_read_b64_tr_b16 v[56:57], v12 offset:8192
    v_mfma_f32_16x16x32_bf16 v[40:43], v[72:75], v[116:119], v[40:43]
    ds_read_b64_tr_b16 v[58:59], v12 offset:9216
    buffer_load_dwordx4 v[140:143], v9, s[60:63], s17 offen offset:0 sc1
    v_mfma_f32_16x16x32_bf16 v[28:31], v[76:79], v[112:115], v[28:31]
    ds_read_b64_tr_b16 v[60:61], v13 offset:8192
    v_mfma_f32_16x16x32_bf16 v[44:47], v[76:79], v[116:119], v[44:47]
    ds_read_b64_tr_b16 v[62:63], v13 offset:9216
    s_waitcnt vmcnt(4) lgkmcnt(4)
    v_mfma_f32_16x16x32_bf16 v[16:19], v[48:51], v[120:123], v[16:19]
    ds_read_b64_tr_b16 v[64:65], v10 offset:12288
    v_mfma_f32_16x16x32_bf16 v[32:35], v[48:51], v[124:127], v[32:35]
    ds_read_b64_tr_b16 v[66:67], v10 offset:13312
    buffer_load_dwordx4 v[144:147], v8, s[60:63], s17 offen offset:2048 sc1
    v_mfma_f32_16x16x32_bf16 v[20:23], v[52:55], v[120:123], v[20:23]
    ds_read_b64_tr_b16 v[68:69], v11 offset:12288
    v_mfma_f32_16x16x32_bf16 v[36:39], v[52:55], v[124:127], v[36:39]
    ds_read_b64_tr_b16 v[70:71], v11 offset:13312
    s_waitcnt lgkmcnt(4)
    v_mfma_f32_16x16x32_bf16 v[24:27], v[56:59], v[120:123], v[24:27]
    ds_read_b64_tr_b16 v[72:73], v12 offset:12288
    v_mfma_f32_16x16x32_bf16 v[40:43], v[56:59], v[124:127], v[40:43]
    ds_read_b64_tr_b16 v[74:75], v12 offset:13312
    buffer_load_dwordx4 v[148:151], v9, s[60:63], s17 offen offset:2048 sc1
    s_add_u32 s17, s17, 4096
    v_mfma_f32_16x16x32_bf16 v[28:31], v[60:63], v[120:123], v[28:31]
    ds_read_b64_tr_b16 v[76:77], v13 offset:12288
    v_mfma_f32_16x16x32_bf16 v[44:47], v[60:63], v[124:127], v[44:47]
    ds_read_b64_tr_b16 v[78:79], v13 offset:13312
    s_waitcnt vmcnt(4) lgkmcnt(4)
    v_mfma_f32_16x16x32_bf16 v[16:19], v[64:67], v[128:131], v[16:19]
    ds_read_b64_tr_b16 v[48:49], v10 offset:16384
    v_add_u32 v80, s37, v4
    v_mfma_f32_16x16x32_bf16 v[32:35], v[64:67], v[132:135], v[32:35]
    ds_read_b64_tr_b16 v[50:51], v10 offset:17408
    buffer_load_dwordx4 v[104:107], v8, s[60:63], s17 offen offset:0 sc1
    v_mfma_f32_16x16x32_bf16 v[20:23], v[68:71], v[128:131], v[20:23]
    ds_read_b64_tr_b16 v[52:53], v11 offset:16384
    v_xor_b32 v81, 0x4000, v80
    v_mfma_f32_16x16x32_bf16 v[36:39], v[68:71], v[132:135], v[36:39]
    ds_read_b64_tr_b16 v[54:55], v11 offset:17408
    s_lshl_b32 s8, s6, 16
    s_waitcnt lgkmcnt(4)
    v_mfma_f32_16x16x32_bf16 v[24:27], v[72:75], v[128:131], v[24:27]
    ds_read_b64_tr_b16 v[56:57], v12 offset:16384
    s_lshl_b32 s9, s93, 8
    v_mfma_f32_16x16x32_bf16 v[40:43], v[72:75], v[132:135], v[40:43]
    ds_read_b64_tr_b16 v[58:59], v12 offset:17408
    buffer_load_dwordx4 v[108:111], v9, s[60:63], s17 offen offset:0 sc1
    v_mfma_f32_16x16x32_bf16 v[28:31], v[76:79], v[128:131], v[28:31]
    ds_read_b64_tr_b16 v[60:61], v13 offset:16384
    s_add_u32 s8, s8, s9
    v_mfma_f32_16x16x32_bf16 v[44:47], v[76:79], v[132:135], v[44:47]
    ds_read_b64_tr_b16 v[62:63], v13 offset:17408
    s_add_u32 s94, s8, 525312
    s_setprio 2
    s_waitcnt vmcnt(4) lgkmcnt(4)
    v_mfma_f32_16x16x32_bf16 v[16:19], v[48:51], v[136:139], v[16:19]
    ds_read_b64_tr_b16 v[64:65], v10 offset:20480
    s_add_u32 s95, s94, 0x4000
    v_mfma_f32_16x16x32_bf16 v[32:35], v[48:51], v[140:143], v[32:35]
    ds_read_b64_tr_b16 v[66:67], v10 offset:21504
    buffer_load_dwordx4 v[112:115], v8, s[60:63], s17 offen offset:2048 sc1
    v_mfma_f32_16x16x32_bf16 v[20:23], v[52:55], v[136:139], v[20:23]
    ds_read_b64_tr_b16 v[68:69], v11 offset:20480
    s_add_u32 s96, s94, 0x8000
    v_mfma_f32_16x16x32_bf16 v[36:39], v[52:55], v[140:143], v[36:39]
    ds_read_b64_tr_b16 v[70:71], v11 offset:21504
    s_add_u32 s97, s94, 0xc000
    s_waitcnt lgkmcnt(4)
    v_mfma_f32_16x16x32_bf16 v[24:27], v[56:59], v[136:139], v[24:27]
    ds_read_b64_tr_b16 v[72:73], v12 offset:20480
    v_and_b32 v82, 0xf0, v4
    v_mfma_f32_16x16x32_bf16 v[40:43], v[56:59], v[140:143], v[40:43]
    ds_read_b64_tr_b16 v[74:75], v12 offset:21504
    buffer_load_dwordx4 v[116:119], v9, s[60:63], s17 offen offset:2048 sc1
    s_add_u32 s17, s17, 4096
    v_mfma_f32_16x16x32_bf16 v[28:31], v[60:63], v[136:139], v[28:31]
    ds_read_b64_tr_b16 v[76:77], v13 offset:20480
    v_lshl_add_u32 v82, v240, 9, v82
    v_mfma_f32_16x16x32_bf16 v[44:47], v[60:63], v[140:143], v[44:47]
    ds_read_b64_tr_b16 v[78:79], v13 offset:21504
    s_lshl_b32 s8, s6, 7
    s_waitcnt vmcnt(4) lgkmcnt(4)
    v_mfma_f32_16x16x32_bf16 v[16:19], v[64:67], v[144:147], v[16:19]
    ds_read_b64_tr_b16 v[48:49], v10 offset:24576
    s_lshl_b32 s9, s93, 4
    v_mfma_f32_16x16x32_bf16 v[32:35], v[64:67], v[148:151], v[32:35]
    ds_read_b64_tr_b16 v[50:51], v10 offset:25600
    buffer_load_dwordx4 v[120:123], v8, s[60:63], s17 offen offset:0 sc1
    v_mfma_f32_16x16x32_bf16 v[20:23], v[68:71], v[144:147], v[20:23]
    ds_read_b64_tr_b16 v[52:53], v11 offset:24576
    s_add_u32 s8, s8, s9
    v_mfma_f32_16x16x32_bf16 v[36:39], v[68:71], v[148:151], v[36:39]
    ds_read_b64_tr_b16 v[54:55], v11 offset:25600
    v_and_b32 v89, 15, v1
    s_waitcnt lgkmcnt(4)
    v_mfma_f32_16x16x32_bf16 v[24:27], v[72:75], v[144:147], v[24:27]
    ds_read_b64_tr_b16 v[56:57], v12 offset:24576
    v_add_u32 v83, s8, v89
    v_mfma_f32_16x16x32_bf16 v[40:43], v[72:75], v[148:151], v[40:43]
    ds_read_b64_tr_b16 v[58:59], v12 offset:25600
    buffer_load_dwordx4 v[124:127], v9, s[60:63], s17 offen offset:0 sc1
    v_mfma_f32_16x16x32_bf16 v[28:31], v[76:79], v[144:147], v[28:31]
    ds_read_b64_tr_b16 v[60:61], v13 offset:24576
    v_lshrrev_b32 v90, 3, v1
    v_mfma_f32_16x16x32_bf16 v[44:47], v[76:79], v[148:151], v[44:47]
    ds_read_b64_tr_b16 v[62:63], v13 offset:25600
    v_add_u32 v92, s8, v90
    s_waitcnt vmcnt(4) lgkmcnt(4)
    v_mfma_f32_16x16x32_bf16 v[16:19], v[48:51], v[104:107], v[16:19]
    ds_read_b64_tr_b16 v[64:65], v10 offset:28672
    s_and_b32 s9, s2, 7
    v_mfma_f32_16x16x32_bf16 v[32:35], v[48:51], v[108:111], v[32:35]
    ds_read_b64_tr_b16 v[66:67], v10 offset:29696
    buffer_load_dwordx4 v[128:131], v8, s[60:63], s17 offen offset:2048 sc1
    v_mfma_f32_16x16x32_bf16 v[20:23], v[52:55], v[104:107], v[20:23]
    ds_read_b64_tr_b16 v[68:69], v11 offset:28672
    s_lshl_b32 s9, s9, 12
    v_mfma_f32_16x16x32_bf16 v[36:39], v[52:55], v[108:111], v[36:39]
    ds_read_b64_tr_b16 v[70:71], v11 offset:29696
    s_add_u32 s9, s9, 524288
    s_waitcnt lgkmcnt(4)
    v_mfma_f32_16x16x32_bf16 v[24:27], v[56:59], v[104:107], v[24:27]
    ds_read_b64_tr_b16 v[72:73], v12 offset:28672
    v_lshl_add_u32 v86, v89, 2, s9
    v_mfma_f32_16x16x32_bf16 v[40:43], v[56:59], v[108:111], v[40:43]
    ds_read_b64_tr_b16 v[74:75], v12 offset:29696
    buffer_load_dwordx4 v[132:135], v9, s[60:63], s17 offen offset:2048 sc1
    s_add_u32 s17, s17, 4096
    v_mfma_f32_16x16x32_bf16 v[28:31], v[60:63], v[104:107], v[28:31]
    ds_read_b64_tr_b16 v[76:77], v13 offset:28672
    v_lshlrev_b32 v87, 12, v1
    v_mfma_f32_16x16x32_bf16 v[44:47], v[60:63], v[108:111], v[44:47]
    ds_read_b64_tr_b16 v[78:79], v13 offset:29696
    s_lshl_b32 s90, s6, 2
    s_waitcnt vmcnt(4) lgkmcnt(4)
    v_mfma_f32_16x16x32_bf16 v[16:19], v[64:67], v[112:115], v[16:19]
    ds_read_b64_tr_b16 v[48:49], v10 offset:32768
    s_add_u32 s90, s90, 524288
    v_mfma_f32_16x16x32_bf16 v[32:35], v[64:67], v[116:119], v[32:35]
    ds_read_b64_tr_b16 v[50:51], v10 offset:33792
    buffer_load_dwordx4 v[136:139], v8, s[60:63], s17 offen offset:0 sc1
    v_mfma_f32_16x16x32_bf16 v[20:23], v[68:71], v[112:115], v[20:23]
    ds_read_b64_tr_b16 v[52:53], v11 offset:32768
    v_cmp_eq_u32 s[32:33], s6, v89
    v_mfma_f32_16x16x32_bf16 v[36:39], v[68:71], v[116:119], v[36:39]
    ds_read_b64_tr_b16 v[54:55], v11 offset:33792
    s_lshl_b32 s8, s3, 2
    s_waitcnt lgkmcnt(4)
    v_mfma_f32_16x16x32_bf16 v[24:27], v[72:75], v[112:115], v[24:27]
    ds_read_b64_tr_b16 v[56:57], v12 offset:32768
    v_mov_b32 v84, s8
    v_mfma_f32_16x16x32_bf16 v[40:43], v[72:75], v[116:119], v[40:43]
    ds_read_b64_tr_b16 v[58:59], v12 offset:33792
    buffer_load_dwordx4 v[140:143], v9, s[60:63], s17 offen offset:0 sc1
    v_mfma_f32_16x16x32_bf16 v[28:31], v[76:79], v[112:115], v[28:31]
    ds_read_b64_tr_b16 v[60:61], v13 offset:32768
    v_mov_b32 v85, 0
    v_mfma_f32_16x16x32_bf16 v[44:47], v[76:79], v[116:119], v[44:47]
    ds_read_b64_tr_b16 v[62:63], v13 offset:33792
    s_mov_b32 s39, 0xfffff800
    s_setprio 1
    s_waitcnt vmcnt(4) lgkmcnt(4)
    v_mfma_f32_16x16x32_bf16 v[16:19], v[48:51], v[120:123], v[16:19]
    ds_read_b64_tr_b16 v[64:65], v10 offset:36864
    v_and_b32 v93, 0x70, v4
    v_mfma_f32_16x16x32_bf16 v[32:35], v[48:51], v[124:127], v[32:35]
    ds_read_b64_tr_b16 v[66:67], v10 offset:37888
    buffer_load_dwordx4 v[144:147], v8, s[60:63], s17 offen offset:2048 sc1
    v_mfma_f32_16x16x32_bf16 v[20:23], v[52:55], v[120:123], v[20:23]
    ds_read_b64_tr_b16 v[68:69], v11 offset:36864
    v_lshl_add_u32 v91, v90, 11, v93
    v_mfma_f32_16x16x32_bf16 v[36:39], v[52:55], v[124:127], v[36:39]
    ds_read_b64_tr_b16 v[70:71], v11 offset:37888
    v_lshl_add_u32 v88, v90, 12, v93
    s_waitcnt lgkmcnt(4)
    v_mfma_f32_16x16x32_bf16 v[24:27], v[56:59], v[120:123], v[24:27]
    ds_read_b64_tr_b16 v[72:73], v12 offset:36864
    v_add_u32 v88, 524672, v88
    v_mfma_f32_16x16x32_bf16 v[40:43], v[56:59], v[124:127], v[40:43]
    ds_read_b64_tr_b16 v[74:75], v12 offset:37888
    buffer_load_dwordx4 v[148:151], v9, s[60:63], s17 offen offset:2048 sc1
    s_add_u32 s17, s17, 4096
    v_mfma_f32_16x16x32_bf16 v[28:31], v[60:63], v[120:123], v[28:31]
    ds_read_b64_tr_b16 v[76:77], v13 offset:36864
    s_mul_i32 s8, s3, 2304
    v_mfma_f32_16x16x32_bf16 v[44:47], v[60:63], v[124:127], v[44:47]
    ds_read_b64_tr_b16 v[78:79], v13 offset:37888
    v_mul_u32_u24 v89, 144, v89
    s_waitcnt vmcnt(4) lgkmcnt(4)
    v_mfma_f32_16x16x32_bf16 v[16:19], v[64:67], v[128:131], v[16:19]
    ds_read_b64_tr_b16 v[48:49], v10 offset:40960
    v_add3_u32 v89, v89, v240, s8
    v_mfma_f32_16x16x32_bf16 v[32:35], v[64:67], v[132:135], v[32:35]
    ds_read_b64_tr_b16 v[50:51], v10 offset:41984
    buffer_load_dwordx4 v[104:107], v8, s[60:63], s17 offen offset:0 sc1
    v_mfma_f32_16x16x32_bf16 v[20:23], v[68:71], v[128:131], v[20:23]
    ds_read_b64_tr_b16 v[52:53], v11 offset:40960
    v_mul_u32_u24 v90, 144, v90
    v_mfma_f32_16x16x32_bf16 v[36:39], v[68:71], v[132:135], v[36:39]
    ds_read_b64_tr_b16 v[54:55], v11 offset:41984
    v_add3_u32 v90, v90, v93, s8
    s_waitcnt lgkmcnt(4)
    v_mfma_f32_16x16x32_bf16 v[24:27], v[72:75], v[128:131], v[24:27]
    ds_read_b64_tr_b16 v[56:57], v12 offset:40960
    s_add_u32 s38, s91, 0x4000
    v_mfma_f32_16x16x32_bf16 v[40:43], v[72:75], v[132:135], v[40:43]
    ds_read_b64_tr_b16 v[58:59], v12 offset:41984
    buffer_load_dwordx4 v[108:111], v9, s[60:63], s17 offen offset:0 sc1
    v_mfma_f32_16x16x32_bf16 v[28:31], v[76:79], v[128:131], v[28:31]
    ds_read_b64_tr_b16 v[60:61], v13 offset:40960
    v_lshrrev_b32 v95, 5, v1
    v_mfma_f32_16x16x32_bf16 v[44:47], v[76:79], v[132:135], v[44:47]
    ds_read_b64_tr_b16 v[62:63], v13 offset:41984
    v_lshl_add_u32 v95, v95, 7, v93
    s_waitcnt vmcnt(4) lgkmcnt(4)
    v_mfma_f32_16x16x32_bf16 v[16:19], v[48:51], v[136:139], v[16:19]
    ds_read_b64_tr_b16 v[64:65], v10 offset:45056
    v_lshlrev_b32 v95, 1, v95
    v_mfma_f32_16x16x32_bf16 v[32:35], v[48:51], v[140:143], v[32:35]
    ds_read_b64_tr_b16 v[66:67], v10 offset:46080
    buffer_load_dwordx4 v[112:115], v8, s[60:63], s17 offen offset:2048 sc1
    v_mfma_f32_16x16x32_bf16 v[20:23], v[52:55], v[136:139], v[20:23]
    ds_read_b64_tr_b16 v[68:69], v11 offset:45056
    s_lshr_b32 s8, s3, 1
    v_mfma_f32_16x16x32_bf16 v[36:39], v[52:55], v[140:143], v[36:39]
    ds_read_b64_tr_b16 v[70:71], v11 offset:46080
    s_lshl_b32 s9, s8, 9
    s_waitcnt lgkmcnt(4)
    v_mfma_f32_16x16x32_bf16 v[24:27], v[56:59], v[136:139], v[24:27]
    ds_read_b64_tr_b16 v[72:73], v12 offset:45056
    s_add_u32 s9, s9, 57344
    v_mfma_f32_16x16x32_bf16 v[40:43], v[56:59], v[140:143], v[40:43]
    ds_read_b64_tr_b16 v[74:75], v12 offset:46080
    buffer_load_dwordx4 v[116:119], v9, s[60:63], s17 offen offset:2048 sc1
    s_add_u32 s17, s17, 4096
    v_mfma_f32_16x16x32_bf16 v[28:31], v[60:63], v[136:139], v[28:31]
    ds_read_b64_tr_b16 v[76:77], v13 offset:45056
    v_lshl_add_u32 v93, v240, 4, s9
    v_mfma_f32_16x16x32_bf16 v[44:47], v[60:63], v[140:143], v[44:47]
    ds_read_b64_tr_b16 v[78:79], v13 offset:46080
    v_and_b32 v94, 2, v1
    s_waitcnt vmcnt(4) lgkmcnt(4)
    v_mfma_f32_16x16x32_bf16 v[16:19], v[64:67], v[144:147], v[16:19]
    ds_read_b64_tr_b16 v[48:49], v10 offset:49152
    v_lshl_add_u32 v93, v94, 5, v93
    v_mfma_f32_16x16x32_bf16 v[32:35], v[64:67], v[148:151], v[32:35]
    ds_read_b64_tr_b16 v[50:51], v10 offset:50176
    buffer_load_dwordx4 v[120:123], v8, s[60:63], s17 offen offset:0 sc1
    v_mfma_f32_16x16x32_bf16 v[20:23], v[68:71], v[144:147], v[20:23]
    ds_read_b64_tr_b16 v[52:53], v11 offset:49152
    v_and_b32 v94, 12, v1
    v_mfma_f32_16x16x32_bf16 v[36:39], v[68:71], v[148:151], v[36:39]
    ds_read_b64_tr_b16 v[54:55], v11 offset:50176
    v_lshl_add_u32 v93, v94, 1, v93
    s_waitcnt lgkmcnt(4)
    v_mfma_f32_16x16x32_bf16 v[24:27], v[72:75], v[144:147], v[24:27]
    ds_read_b64_tr_b16 v[56:57], v12 offset:49152
    s_lshl_b32 s8, s8, 2
    v_mfma_f32_16x16x32_bf16 v[40:43], v[72:75], v[148:151], v[40:43]
    ds_read_b64_tr_b16 v[58:59], v12 offset:50176
    buffer_load_dwordx4 v[124:127], v9, s[60:63], s17 offen offset:0 sc1
    v_mfma_f32_16x16x32_bf16 v[28:31], v[76:79], v[144:147], v[28:31]
    ds_read_b64_tr_b16 v[60:61], v13 offset:49152
    s_and_b32 s9, s3, 1
    v_mfma_f32_16x16x32_bf16 v[44:47], v[76:79], v[148:151], v[44:47]
    ds_read_b64_tr_b16 v[62:63], v13 offset:50176
    s_lshl_b32 s9, s9, 4
    s_setprio 0
    s_waitcnt vmcnt(4) lgkmcnt(4)
    v_mfma_f32_16x16x32_bf16 v[16:19], v[48:51], v[104:107], v[16:19]
    ds_read_b64_tr_b16 v[64:65], v10 offset:53248
    s_add_u32 s8, s8, s9
    v_mfma_f32_16x16x32_bf16 v[32:35], v[48:51], v[108:111], v[32:35]
    ds_read_b64_tr_b16 v[66:67], v10 offset:54272
    buffer_load_dwordx4 v[128:131], v8, s[60:63], s17 offen offset:2048 sc1
    v_mfma_f32_16x16x32_bf16 v[20:23], v[52:55], v[104:107], v[20:23]
    ds_read_b64_tr_b16 v[68:69], v11 offset:53248
    s_add_u32 s8, s8, 33024
    v_mfma_f32_16x16x32_bf16 v[36:39], v[52:55], v[108:111], v[36:39]
    ds_read_b64_tr_b16 v[70:71], v11 offset:54272
    v_and_b32 v94, 16, v4
    s_waitcnt lgkmcnt(4)
    v_mfma_f32_16x16x32_bf16 v[24:27], v[56:59], v[104:107], v[24:27]
    ds_read_b64_tr_b16 v[72:73], v12 offset:53248
    v_lshl_add_u32 v94, v94, 4, s8
    v_mfma_f32_16x16x32_bf16 v[40:43], v[56:59], v[108:111], v[40:43]
    ds_read_b64_tr_b16 v[74:75], v12 offset:54272
    buffer_load_dwordx4 v[132:135], v9, s[60:63], s17 offen offset:2048 sc1
    s_add_u32 s17, s17, 4096
    v_mfma_f32_16x16x32_bf16 v[28:31], v[60:63], v[104:107], v[28:31]
    ds_read_b64_tr_b16 v[76:77], v13 offset:53248
    v_lshl_add_u32 v94, v240, 3, v94
    v_mfma_f32_16x16x32_bf16 v[44:47], v[60:63], v[108:111], v[44:47]
    ds_read_b64_tr_b16 v[78:79], v13 offset:54272
    s_waitcnt vmcnt(4) lgkmcnt(4)
    v_mfma_f32_16x16x32_bf16 v[16:19], v[64:67], v[112:115], v[16:19]
    ds_read_b64_tr_b16 v[48:49], v10 offset:57344
    v_mfma_f32_16x16x32_bf16 v[32:35], v[64:67], v[116:119], v[32:35]
    ds_read_b64_tr_b16 v[50:51], v10 offset:58368
    v_mfma_f32_16x16x32_bf16 v[20:23], v[68:71], v[112:115], v[20:23]
    ds_read_b64_tr_b16 v[52:53], v11 offset:57344
    v_mfma_f32_16x16x32_bf16 v[36:39], v[68:71], v[116:119], v[36:39]
    ds_read_b64_tr_b16 v[54:55], v11 offset:58368
    s_waitcnt lgkmcnt(4)
    v_mfma_f32_16x16x32_bf16 v[24:27], v[72:75], v[112:115], v[24:27]
    ds_read_b64_tr_b16 v[56:57], v12 offset:57344
    v_mfma_f32_16x16x32_bf16 v[40:43], v[72:75], v[116:119], v[40:43]
    ds_read_b64_tr_b16 v[58:59], v12 offset:58368
    v_mfma_f32_16x16x32_bf16 v[28:31], v[76:79], v[112:115], v[28:31]
    ds_read_b64_tr_b16 v[60:61], v13 offset:57344
    v_mfma_f32_16x16x32_bf16 v[44:47], v[76:79], v[116:119], v[44:47]
    ds_read_b64_tr_b16 v[62:63], v13 offset:58368
    s_setprio 0
    s_waitcnt vmcnt(2) lgkmcnt(4)
    v_mfma_f32_16x16x32_bf16 v[32:35], v[48:51], v[124:127], v[32:35]
    ds_read_b64_tr_b16 v[64:65], v10 offset:61440
    ds_read_b64_tr_b16 v[66:67], v10 offset:62464
    v_mfma_f32_16x16x32_bf16 v[36:39], v[52:55], v[124:127], v[36:39]
    ds_read_b64_tr_b16 v[68:69], v11 offset:61440
    ds_read_b64_tr_b16 v[70:71], v11 offset:62464
    s_waitcnt lgkmcnt(4)
    v_mfma_f32_16x16x32_bf16 v[40:43], v[56:59], v[124:127], v[40:43]
    ds_read_b64_tr_b16 v[72:73], v12 offset:61440
    ds_read_b64_tr_b16 v[74:75], v12 offset:62464
    v_mfma_f32_16x16x32_bf16 v[44:47], v[60:63], v[124:127], v[44:47]
    ds_read_b64_tr_b16 v[76:77], v13 offset:61440
    ds_read_b64_tr_b16 v[78:79], v13 offset:62464
    v_mfma_f32_16x16x32_bf16 v[16:19], v[48:51], v[120:123], v[16:19]
    v_mfma_f32_16x16x32_bf16 v[20:23], v[52:55], v[120:123], v[20:23]
    s_waitcnt vmcnt(0) lgkmcnt(6)
    v_mfma_f32_16x16x32_bf16 v[32:35], v[64:67], v[132:135], v[32:35]
    s_waitcnt vmcnt(0) lgkmcnt(4)
    v_mfma_f32_16x16x32_bf16 v[36:39], v[68:71], v[132:135], v[36:39]
    s_waitcnt vmcnt(0) lgkmcnt(2)
    v_mfma_f32_16x16x32_bf16 v[40:43], v[72:75], v[132:135], v[40:43]
    s_waitcnt vmcnt(0) lgkmcnt(0)
    v_mfma_f32_16x16x32_bf16 v[44:47], v[76:79], v[132:135], v[44:47]
    v_mfma_f32_16x16x32_bf16 v[24:27], v[56:59], v[120:123], v[24:27]
    v_mfma_f32_16x16x32_bf16 v[28:31], v[60:63], v[120:123], v[28:31]
    v_mfma_f32_16x16x32_bf16 v[16:19], v[64:67], v[128:131], v[16:19]
    ds_write_b128 v80, v[32:35] offset:0
    v_mfma_f32_16x16x32_bf16 v[20:23], v[68:71], v[128:131], v[20:23]
    ds_write_b128 v80, v[36:39] offset:1024
    v_mfma_f32_16x16x32_bf16 v[24:27], v[72:75], v[128:131], v[24:27]
    ds_write_b128 v80, v[40:43] offset:2048
    v_mfma_f32_16x16x32_bf16 v[28:31], v[76:79], v[128:131], v[28:31]
    ds_write_b128 v80, v[44:47] offset:3072
    s_waitcnt lgkmcnt(0)
    s_barrier
    ds_read_b128 v[32:35], v81 offset:0
    ds_read_b128 v[36:39], v81 offset:1024
    ds_read_b128 v[40:43], v81 offset:2048
    ds_read_b128 v[44:47], v81 offset:3072
    s_waitcnt lgkmcnt(3)
    v_pk_add_f32 v[16:17], v[16:17], v[32:33]
    v_pk_add_f32 v[18:19], v[18:19], v[34:35]
    v_pk_mul_f32 v[98:99], v[16:17], v[16:17]
    v_pk_mul_f32 v[100:101], v[16:17], v[152:153]
    v_pk_add_f32 v[96:97], v[18:19], v[16:17]
    v_pk_fma_f32 v[98:99], v[18:19], v[18:19], v[98:99]
    v_pk_fma_f32 v[100:101], v[18:19], v[154:155], v[100:101]
    s_waitcnt lgkmcnt(2)
    v_pk_add_f32 v[20:21], v[20:21], v[36:37]
    v_pk_add_f32 v[22:23], v[22:23], v[38:39]
    v_pk_add_f32 v[96:97], v[20:21], v[96:97]
    v_pk_fma_f32 v[98:99], v[20:21], v[20:21], v[98:99]
    v_pk_fma_f32 v[100:101], v[20:21], v[156:157], v[100:101]
    v_pk_add_f32 v[96:97], v[22:23], v[96:97]
    v_pk_fma_f32 v[98:99], v[22:23], v[22:23], v[98:99]
    v_pk_fma_f32 v[100:101], v[22:23], v[158:159], v[100:101]
    s_waitcnt lgkmcnt(1)
    v_pk_add_f32 v[24:25], v[24:25], v[40:41]
    v_pk_add_f32 v[26:27], v[26:27], v[42:43]
    v_pk_add_f32 v[96:97], v[24:25], v[96:97]
    v_pk_fma_f32 v[98:99], v[24:25], v[24:25], v[98:99]
    v_pk_fma_f32 v[100:101], v[24:25], v[160:161], v[100:101]
    v_pk_add_f32 v[96:97], v[26:27], v[96:97]
    v_pk_fma_f32 v[98:99], v[26:27], v[26:27], v[98:99]
    v_pk_fma_f32 v[100:101], v[26:27], v[162:163], v[100:101]
    s_waitcnt lgkmcnt(0)
    v_pk_add_f32 v[28:29], v[28:29], v[44:45]
    v_pk_add_f32 v[30:31], v[30:31], v[46:47]
    v_pk_add_f32 v[96:97], v[28:29], v[96:97]
    v_pk_fma_f32 v[98:99], v[28:29], v[28:29], v[98:99]
    v_pk_fma_f32 v[100:101], v[28:29], v[164:165], v[100:101]
    v_pk_add_f32 v[96:97], v[30:31], v[96:97]
    v_pk_fma_f32 v[98:99], v[30:31], v[30:31], v[98:99]
    v_pk_fma_f32 v[100:101], v[30:31], v[166:167], v[100:101]
    v_add_f32 v96, v96, v97
    v_add_f32 v98, v98, v99
    v_add_f32 v100, v100, v101
    s_cmp_eq_u32 s25, 1
    v_permlane32_swap_b32 v96, v98
    v_permlane32_swap_b32 v100, v168
    v_add_f32 v96, v96, v98
    v_add_f32 v100, v100, v168
    s_nop 1
    v_permlane16_swap_b32 v96, v100
    v_add_f32 v96, v96, v100
    v_min_u32 v241, -2, v96
    s_cbranch_scc1 L_st_fast
    buffer_store_dword v241, v6, s[60:63], 0 offen sc1
    s_branch L_st_done
L_st_fast:
    buffer_store_dword v241, v6, s[60:63], 0 offen
L_st_done:
    v_perm_b32 v170, v176, v172, s12
    v_perm_b32 v176, v176, v172, s13
    v_perm_b32 v172, v177, v173, s12
    v_perm_b32 v177, v177, v173, s13
    v_perm_b32 v173, v178, v174, s12
    v_perm_b32 v178, v178, v174, s13
    v_perm_b32 v174, v179, v175, s12
    v_perm_b32 v179, v179, v175, s13
    v_perm_b32 v175, v184, v180, s12
    v_perm_b32 v184, v184, v180, s13
    v_perm_b32 v180, v185, v181, s12
    v_perm_b32 v185, v185, v181, s13
    v_perm_b32 v181, v186, v182, s12
    v_perm_b32 v186, v186, v182, s13
    v_perm_b32 v182, v187, v183, s12
    v_perm_b32 v187, v187, v183, s13
    s_waitcnt vmcnt(0)
    buffer_load_dwordx4 v[96:99], v82, s[60:63], s94 offen sc1
    buffer_load_dwordx4 v[100:103], v82, s[60:63], s95 offen sc1
    buffer_load_dwordx4 v[104:107], v82, s[60:63], s96 offen sc1
    buffer_load_dwordx4 v[108:111], v82, s[60:63], s97 offen sc1
L_s3:
    s_waitcnt vmcnt(0)
    v_max_u32 v14, v96, v97
    v_max3_u32 v14, v98, v99, v14
    v_max3_u32 v14, v100, v101, v14
    v_max3_u32 v14, v102, v103, v14
    v_max3_u32 v14, v104, v105, v14
    v_max3_u32 v14, v106, v107, v14
    v_max3_u32 v14, v108, v109, v14
    v_max3_u32 v14, v110, v111, v14
    v_cmp_eq_u32 vcc, -1, v14
    s_nop 0
    s_cbranch_vccz L_s3_ok
    buffer_load_dwordx4 v[96:99], v82, s[60:63], s94 offen sc1
    buffer_load_dwordx4 v[100:103], v82, s[60:63], s95 offen sc1
    buffer_load_dwordx4 v[104:107], v82, s[60:63], s96 offen sc1
    buffer_load_dwordx4 v[108:111], v82, s[60:63], s97 offen sc1
    s_add_u32 s26, s26, 1
    s_cmp_lt_u32 s26, 200000
    s_cbranch_scc1 L_s3
    s_waitcnt vmcnt(0)
L_s3_ok:
    s_cmp_eq_u32 s3, 7
    s_cbranch_scc0 L_noks
    buffer_load_dword v149, v86, s[60:63], 0 offen sc1
    s_setprio 1
L_noks:
    v_pk_add_f32 v[96:97], v[96:97], v[100:101]
    v_pk_add_f32 v[104:105], v[104:105], v[108:109]
    v_pk_add_f32 v[98:99], v[98:99], v[102:103]
    v_pk_add_f32 v[106:107], v[106:107], v[110:111]
    v_pk_add_f32 v[96:97], v[96:97], v[104:105]
    v_pk_add_f32 v[98:99], v[98:99], v[106:107]
    s_nop 1
    v_permlane32_swap_b32 v96, v98
    v_permlane32_swap_b32 v97, v99
    v_pk_add_f32 v[96:97], v[96:97], v[98:99]
    s_nop 1
    v_permlane16_swap_b32 v96, v97
    v_add_f32 v98, v96, v97
    v_add_f32 v96, v96, v97
    s_nop 1
    v_permlane32_swap_b32 v96, v98
    v_mov_b32 v97, v96
    v_mov_b32 v99, v98
    s_nop 0
    v_permlane16_swap_b32 v96, v97
    v_permlane16_swap_b32 v98, v99
    v_mul_f32 v96, 0x3a800000, v96
    v_mul_f32 v100, v96, v96
    v_sub_f32 v100, 0x3727c5ac, v100
    v_fmamk_f32 v98, v98, 0x3a800000, v100
    v_max_f32 v98, 0x3727c5ac, v98
    v_rsq_f32 v117, v98
    v_fma_f32 v97, -v96, v99, v97
    v_mul_f32 v97, v97, v117
    v_ashrrev_i32 v99, 31, v97
    v_or_b32 v99, 0x80000000, v99
    v_xor_b32 v97, v97, v99
    v_min_u32 v97, 0xfffff000, v97
    v_and_or_b32 v97, v97, s39, v83
    v_mul_f32 v116, v96, v117
    v_add_f32 v118, 1.0, v117
    v_max_u32_dpp v97, v97, v97 row_ror:8 row_mask:0xf bank_mask:0xf
    s_nop 1
    v_max_u32_dpp v97, v97, v97 row_ror:4 row_mask:0xf bank_mask:0xf
    s_nop 1
    v_max_u32_dpp v97, v97, v97 row_ror:2 row_mask:0xf bank_mask:0xf
    s_nop 1
    v_max_u32_dpp v97, v97, v97 row_ror:1 row_mask:0xf bank_mask:0xf
    s_mov_b64 exec, 1
    ds_write_b32 v84, v97 offset:32768
    s_mov_b64 exec, -1
    s_lshl_b32 s8, s7, 3
    s_add_u32 s8, s8, s3
    s_waitcnt lgkmcnt(0)
    s_barrier
    ds_read_b128 v[100:103], v85 offset:32768
    ds_read_b128 v[104:107], v85 offset:32784
    v_pk_fma_f32 v[32:33], v[16:17], v[118:119], v[116:117] op_sel_hi:[1,0,0] neg_lo:[0,0,1] neg_hi:[0,0,1]
    v_pk_fma_f32 v[34:35], v[18:19], v[118:119], v[116:117] op_sel_hi:[1,0,0] neg_lo:[0,0,1] neg_hi:[0,0,1]
    v_pk_fma_f32 v[36:37], v[20:21], v[118:119], v[116:117] op_sel_hi:[1,0,0] neg_lo:[0,0,1] neg_hi:[0,0,1]
    v_pk_fma_f32 v[38:39], v[22:23], v[118:119], v[116:117] op_sel_hi:[1,0,0] neg_lo:[0,0,1] neg_hi:[0,0,1]
    v_pk_fma_f32 v[40:41], v[24:25], v[118:119], v[116:117] op_sel_hi:[1,0,0] neg_lo:[0,0,1] neg_hi:[0,0,1]
    v_pk_fma_f32 v[42:43], v[26:27], v[118:119], v[116:117] op_sel_hi:[1,0,0] neg_lo:[0,0,1] neg_hi:[0,0,1]
    v_pk_fma_f32 v[44:45], v[28:29], v[118:119], v[116:117] op_sel_hi:[1,0,0] neg_lo:[0,0,1] neg_hi:[0,0,1]
    v_pk_fma_f32 v[46:47], v[30:31], v[118:119], v[116:117] op_sel_hi:[1,0,0] neg_lo:[0,0,1] neg_hi:[0,0,1]
    s_cmp_eq_u32 s8, 0
    s_waitcnt vmcnt(0) lgkmcnt(0)
    v_max3_u32 v100, v100, v101, v102
    v_max3_u32 v104, v104, v105, v106
    v_max3_u32 v100, v100, v103, v107
    v_max_u32 v151, v100, v104
    s_cbranch_scc0 L_nokey
    s_mov_b64 exec, 255
    buffer_store_dword v151, v87, s[60:63], s90 offen sc1
    s_mov_b64 exec, -1
L_nokey:
    v_and_b32 v108, 0x7ff, v151
    v_cmp_eq_u32 vcc, v108, v83
    s_nop 0
    s_cbranch_vccz L_notown
    v_pk_fma_f32 v[16:17], v[16:17], v[116:117], v[116:117] op_sel:[0,1,0] op_sel_hi:[1,1,0] neg_lo:[0,0,1] neg_hi:[0,0,1]
    v_pk_fma_f32 v[18:19], v[18:19], v[116:117], v[116:117] op_sel:[0,1,0] op_sel_hi:[1,1,0] neg_lo:[0,0,1] neg_hi:[0,0,1]
    v_pk_fma_f32 v[20:21], v[20:21], v[116:117], v[116:117] op_sel:[0,1,0] op_sel_hi:[1,1,0] neg_lo:[0,0,1] neg_hi:[0,0,1]
    v_pk_fma_f32 v[22:23], v[22:23], v[116:117], v[116:117] op_sel:[0,1,0] op_sel_hi:[1,1,0] neg_lo:[0,0,1] neg_hi:[0,0,1]
    v_pk_fma_f32 v[24:25], v[24:25], v[116:117], v[116:117] op_sel:[0,1,0] op_sel_hi:[1,1,0] neg_lo:[0,0,1] neg_hi:[0,0,1]
    v_pk_fma_f32 v[26:27], v[26:27], v[116:117], v[116:117] op_sel:[0,1,0] op_sel_hi:[1,1,0] neg_lo:[0,0,1] neg_hi:[0,0,1]
    v_pk_fma_f32 v[28:29], v[28:29], v[116:117], v[116:117] op_sel:[0,1,0] op_sel_hi:[1,1,0] neg_lo:[0,0,1] neg_hi:[0,0,1]
    v_pk_fma_f32 v[30:31], v[30:31], v[116:117], v[116:117] op_sel:[0,1,0] op_sel_hi:[1,1,0] neg_lo:[0,0,1] neg_hi:[0,0,1]
    v_cvt_pk_bf16_f32 v96, v16, v17
    v_min_u32 v96, -2, v96
    v_cvt_pk_bf16_f32 v97, v18, v19
    v_min_u32 v97, -2, v97
    v_cvt_pk_bf16_f32 v98, v20, v21
    v_min_u32 v98, -2, v98
    v_cvt_pk_bf16_f32 v99, v22, v23
    v_min_u32 v99, -2, v99
    v_cvt_pk_bf16_f32 v100, v24, v25
    v_min_u32 v100, -2, v100
    v_cvt_pk_bf16_f32 v101, v26, v27
    v_min_u32 v101, -2, v101
    v_cvt_pk_bf16_f32 v102, v28, v29
    v_min_u32 v102, -2, v102
    v_cvt_pk_bf16_f32 v103, v30, v31
    v_min_u32 v103, -2, v103
    v_lshlrev_b32 v15, 2, v240
    s_mov_b64 exec, vcc
    buffer_store_dwordx4 v[96:99], v15, s[60:63], s24 offen offset:384 sc1
    buffer_store_dwordx4 v[100:103], v15, s[60:63], s24 offen offset:400 sc1
    v_lshlrev_b32 v14, 1, v240
    v_min_u32 v16, -2, v32
    v_min_u32 v17, -2, v33
    v_min_u32 v18, -2, v34
    v_min_u32 v19, -2, v35
    v_min_u32 v20, -2, v36
    v_min_u32 v21, -2, v37
    v_min_u32 v22, -2, v38
    v_min_u32 v23, -2, v39
    v_min_u32 v24, -2, v40
    v_min_u32 v25, -2, v41
    v_min_u32 v26, -2, v42
    v_min_u32 v27, -2, v43
    v_min_u32 v28, -2, v44
    v_min_u32 v29, -2, v45
    v_min_u32 v30, -2, v46
    v_min_u32 v31, -2, v47
    buffer_store_dwordx4 v[16:19], v14, s[60:63], s24 offen offset:512 sc1
    buffer_store_dwordx4 v[20:23], v14, s[60:63], s24 offen offset:576 sc1
    buffer_store_dwordx4 v[24:27], v14, s[60:63], s24 offen offset:640 sc1
    buffer_store_dwordx4 v[28:31], v14, s[60:63], s24 offen offset:704 sc1
    s_mov_b64 exec, -1
L_notown:
    s_cmp_eq_u32 s3, 7
    s_cbranch_scc0 L_kwork
    v_cndmask_b32 v149, v149, 0, s[32:33]
    v_add_u32 v149, 1, v149
    s_nop 1
    v_max_u32_dpp v149, v149, v149 row_ror:8 row_mask:0xf bank_mask:0xf
    s_nop 1
    v_max_u32_dpp v149, v149, v149 row_ror:4 row_mask:0xf bank_mask:0xf
    s_nop 1
    v_max_u32_dpp v149, v149, v149 row_ror:2 row_mask:0xf bank_mask:0xf
    s_nop 1
    v_max_u32_dpp v149, v149, v149 row_ror:1 row_mask:0xf bank_mask:0xf
    s_nop 0
    v_readfirstlane_b32 s27, v149
    s_nop 0
    s_sub_u32 s27, s27, 1
    s_bfe_u32 s8, s27, 0x40007
    s_lshl_b32 s8, s8, 16
    s_cmp_eq_u32 s27, 0
    s_cselect_b32 s8, 0x40000000, s8
    s_add_u32 s9, s8, 0x8000
    buffer_load_dwordx4 v[120:123], v88, s[60:63], s8 offen sc1
    buffer_load_dwordx4 v[124:127], v88, s[60:63], s9 offen sc1
    buffer_load_dword v149, v86, s[60:63], 0 offen sc1
L_kwork:
    v_cvt_pk_bf16_f32 v136, v32, v33
    v_cvt_pk_bf16_f32 v137, v34, v35
    ds_write_b64 v89, v[136:137] offset:36864
    v_cvt_pk_bf16_f32 v138, v36, v37
    v_cvt_pk_bf16_f32 v139, v38, v39
    ds_write_b64 v89, v[138:139] offset:36896
    v_cvt_pk_bf16_f32 v140, v40, v41
    v_cvt_pk_bf16_f32 v141, v42, v43
    ds_write_b64 v89, v[140:141] offset:36928
    v_cvt_pk_bf16_f32 v142, v44, v45
    v_cvt_pk_bf16_f32 v143, v46, v47
    ds_write_b64 v89, v[142:143] offset:36960
    ds_read_b128 v[136:139], v90 offset:36864
    ds_read_b128 v[140:143], v90 offset:38016
    v_perm_b32 v183, v192, v188, s12
    v_perm_b32 v192, v192, v188, s13
    v_perm_b32 v188, v193, v189, s12
    v_perm_b32 v193, v193, v189, s13
    v_perm_b32 v189, v194, v190, s12
    v_perm_b32 v194, v194, v190, s13
    v_perm_b32 v190, v195, v191, s12
    v_perm_b32 v195, v195, v191, s13
    v_perm_b32 v191, v200, v196, s12
    v_perm_b32 v200, v200, v196, s13
    v_perm_b32 v196, v201, v197, s12
    v_perm_b32 v201, v201, v197, s13
    v_perm_b32 v197, v202, v198, s12
    v_perm_b32 v202, v202, v198, s13
    v_perm_b32 v198, v203, v199, s12
    v_perm_b32 v203, v203, v199, s13
    v_perm_b32 v199, v206, v204, s12
    v_perm_b32 v206, v206, v204, s13
    v_perm_b32 v204, v207, v205, s12
    v_perm_b32 v207, v207, v205, s13
    v_perm_b32 v205, v210, v208, s12
    v_perm_b32 v210, v210, v208, s13
    v_perm_b32 v208, v211, v209, s12
    v_perm_b32 v211, v211, v209, s13
    v_perm_b32 v209, v214, v212, s12
    v_perm_b32 v214, v214, v212, s13
    v_perm_b32 v212, v215, v213, s12
    v_perm_b32 v215, v215, v213, s13
    v_perm_b32 v213, v218, v216, s12
    v_perm_b32 v218, v218, v216, s13
    v_perm_b32 v216, v219, v217, s12
    v_perm_b32 v219, v219, v217, s13
    s_cmp_eq_u32 s3, 7
    s_cbranch_scc0 L_kwait
L_key:
    v_mov_b32 v15, s27
    s_waitcnt vmcnt(1)
    ds_write_b128 v4, v[120:123] offset:57344
    ds_write_b128 v4, v[124:127] offset:58368
    ds_write_b32 v85, v15 offset:32832
    v_max_u32 v14, v120, v121
    v_max3_u32 v14, v122, v123, v14
    v_max3_u32 v14, v124, v125, v14
    v_max3_u32 v14, v126, v127, v14
    v_cmp_eq_u32 vcc, -1, v14
    s_nop 0
    s_cbranch_vccnz L_key_row
L_keyb:
    s_waitcnt vmcnt(0)
    v_cndmask_b32 v149, v149, v151, s[32:33]
    v_cmp_lt_u32 vcc, s27, v149
    v_cmp_ne_u32 s[98:99], -1, v149
    s_cbranch_vccz L_key_ok
    s_and_b64 s[98:99], s[98:99], vcc
    s_cbranch_scc1 L_key_row
    buffer_load_dword v149, v86, s[60:63], 0 offen sc1
    s_add_u32 s26, s26, 1
    s_cmp_lt_u32 s26, 200000
    s_cbranch_scc1 L_keyb
L_key_row:
    s_waitcnt vmcnt(0)
    v_cndmask_b32 v149, v149, v151, s[32:33]
    v_add_u32 v149, 1, v149
    s_nop 1
    v_max_u32_dpp v149, v149, v149 row_ror:8 row_mask:0xf bank_mask:0xf
    s_nop 1
    v_max_u32_dpp v149, v149, v149 row_ror:4 row_mask:0xf bank_mask:0xf
    s_nop 1
    v_max_u32_dpp v149, v149, v149 row_ror:2 row_mask:0xf bank_mask:0xf
    s_nop 1
    v_max_u32_dpp v149, v149, v149 row_ror:1 row_mask:0xf bank_mask:0xf
    s_nop 0
    v_readfirstlane_b32 s27, v149
    s_nop 0
    s_sub_u32 s27, s27, 1
    s_bfe_u32 s8, s27, 0x40007
    s_lshl_b32 s8, s8, 16
    s_add_u32 s9, s8, 0x8000
    buffer_load_dwordx4 v[120:123], v88, s[60:63], s8 offen sc1
    buffer_load_dwordx4 v[124:127], v88, s[60:63], s9 offen sc1
    buffer_load_dword v149, v86, s[60:63], 0 offen sc1
    s_add_u32 s26, s26, 1
    s_cmp_lt_u32 s26, 200000
    s_cbranch_scc1 L_key
L_key_ok:
    s_waitcnt lgkmcnt(0)
    s_setprio 0
L_kwait:
    s_barrier
    ds_read2_b64 v[96:99], v93 offset0:0 offset1:4
    ds_read_b32 v15, v85 offset:32832
    s_cmp_lt_u32 s28, 28
    s_waitcnt lgkmcnt(0)
    v_readfirstlane_b32 s27, v15
    s_cbranch_scc1 L_ffn
    s_and_b32 s31, s27, 0x7ff
    v_cmp_ne_u32 vcc, s31, v92
    s_sub_u32 s39, s31, 8
    v_cmp_ne_u32 s[98:99], s39, v92
    s_mov_b64 exec, vcc
    buffer_store_dwordx4 v[136:139], v91, s[64:67], s91 offen sc1
    s_mov_b64 exec, s[98:99]
    buffer_store_dwordx4 v[140:143], v91, s[64:67], s38 offen sc1
    s_mov_b64 exec, -1
    s_endpgm
L_ffn:
    s_and_b32 s31, s27, 0x7ff
    v_cmp_ne_u32 vcc, s31, v92
    s_sub_u32 s39, s31, 8
    v_cmp_ne_u32 s[98:99], s39, v92
    s_mov_b64 exec, vcc
    buffer_store_dwordx4 v[136:139], v91, s[64:67], s91 offen sc1
    s_mov_b64 exec, s[98:99]
    buffer_store_dwordx4 v[140:143], v91, s[64:67], s38 offen sc1
    s_mov_b64 exec, -1
    v_dot2_f32_bf16 v104, v170, v96, 0
    v_dot2_f32_bf16 v105, v176, v96, 0
    v_dot2_f32_bf16 v106, v172, v96, 0
    v_dot2_f32_bf16 v107, v177, v96, 0
    v_dot2_f32_bf16 v108, v173, v96, 0
    v_dot2_f32_bf16 v109, v178, v96, 0
    v_dot2_f32_bf16 v110, v174, v96, 0
    v_dot2_f32_bf16 v111, v179, v96, 0
    v_dot2c_f32_bf16 v104, v175, v97
    v_dot2c_f32_bf16 v105, v184, v97
    v_dot2c_f32_bf16 v106, v180, v97
    v_dot2c_f32_bf16 v107, v185, v97
    v_dot2c_f32_bf16 v108, v181, v97
    v_dot2c_f32_bf16 v109, v186, v97
    v_dot2c_f32_bf16 v110, v182, v97
    v_dot2c_f32_bf16 v111, v187, v97
    v_dot2c_f32_bf16 v104, v183, v98
    v_dot2c_f32_bf16 v105, v192, v98
    v_dot2c_f32_bf16 v106, v188, v98
    v_dot2c_f32_bf16 v107, v193, v98
    v_dot2c_f32_bf16 v108, v189, v98
    v_dot2c_f32_bf16 v109, v194, v98
    v_dot2c_f32_bf16 v110, v190, v98
    v_dot2c_f32_bf16 v111, v195, v98
    v_dot2c_f32_bf16 v104, v191, v99
    v_dot2c_f32_bf16 v105, v200, v99
    v_dot2c_f32_bf16 v106, v196, v99
    v_dot2c_f32_bf16 v107, v201, v99
    v_dot2c_f32_bf16 v108, v197, v99
    v_dot2c_f32_bf16 v109, v202, v99
    v_dot2c_f32_bf16 v110, v198, v99
    v_dot2c_f32_bf16 v111, v203, v99
    v_permlane32_swap_b32 v104, v108
    v_permlane32_swap_b32 v105, v109
    v_permlane32_swap_b32 v106, v110
    v_permlane32_swap_b32 v107, v111
    v_pk_add_f32 v[104:105], v[104:105], v[108:109]
    v_pk_add_f32 v[106:107], v[106:107], v[110:111]
    s_nop 1
    v_permlane16_swap_b32 v104, v106
    v_permlane16_swap_b32 v105, v107
    v_pk_add_f32 v[104:105], v[104:105], v[106:107]
    s_nop 1
    v_add_f32_dpp v104, v104, v104 row_ror:8 row_mask:0xf bank_mask:0xf
    v_add_f32_dpp v105, v105, v105 row_ror:8 row_mask:0xf bank_mask:0xf
    s_nop 0
    v_add_f32_dpp v104, v104, v104 row_ror:4 row_mask:0xf bank_mask:0xf
    v_add_f32_dpp v105, v105, v105 row_ror:4 row_mask:0xf bank_mask:0xf
    s_nop 0
    v_add_f32_dpp v104, v104, v104 row_ror:2 row_mask:0xf bank_mask:0xf
    v_add_f32_dpp v105, v105, v105 row_ror:2 row_mask:0xf bank_mask:0xf
    s_mov_b32 exec_lo, 0x00030003
    s_mov_b32 exec_hi, 0x00030003
    ds_write2_b32 v94, v104, v105 offset0:0 offset1:8
    s_mov_b64 exec, -1
    s_waitcnt lgkmcnt(0)
    s_barrier
    ds_read_b128 v[96:99], v95 offset:33024
    ds_read_b128 v[100:103], v95 offset:33040
    s_waitcnt lgkmcnt(1)
    v_pk_add_f32 v[96:97], v[96:97], v[98:99]
    v_add_f32 v96, v96, v97
    v_mul_f32 v97, 0xbfb8aa3b, v96
    v_exp_f32 v97, v97
    s_waitcnt lgkmcnt(0)
    v_add_f32 v97, 1.0, v97
    v_rcp_f32 v97, v97
    v_pk_add_f32 v[100:101], v[100:101], v[102:103]
    v_add_f32 v100, v100, v101
    v_mul_f32 v96, v96, v97
    v_mul_f32 v96, v96, v100
    s_nop 1
    v_mov_b32_dpp v97, v96 quad_perm:[1,0,3,2] row_mask:0xf bank_mask:0xf
    v_cvt_pk_bf16_f32 v96, v96, v97
    s_nop 1
    v_mov_b32_dpp v100, v96 row_newbcast:0 row_mask:0xf bank_mask:0xf
    v_mov_b32_dpp v101, v96 row_newbcast:2 row_mask:0xf bank_mask:0xf
    v_mov_b32_dpp v102, v96 row_newbcast:4 row_mask:0xf bank_mask:0xf
    v_mov_b32_dpp v103, v96 row_newbcast:6 row_mask:0xf bank_mask:0xf
    v_dot2_f32_bf16 v104, v199, v100, 0
    v_dot2_f32_bf16 v105, v206, v100, 0
    v_dot2_f32_bf16 v106, v204, v100, 0
    v_dot2_f32_bf16 v107, v207, v100, 0
    v_dot2c_f32_bf16 v104, v205, v101
    v_dot2c_f32_bf16 v105, v210, v101
    v_dot2c_f32_bf16 v106, v208, v101
    v_dot2c_f32_bf16 v107, v211, v101
    v_dot2c_f32_bf16 v104, v209, v102
    v_dot2c_f32_bf16 v105, v214, v102
    v_dot2c_f32_bf16 v106, v212, v102
    v_dot2c_f32_bf16 v107, v215, v102
    v_dot2c_f32_bf16 v104, v213, v103
    v_dot2c_f32_bf16 v105, v218, v103
    v_dot2c_f32_bf16 v106, v216, v103
    v_dot2c_f32_bf16 v107, v219, v103
    s_nop 1
    v_permlane32_swap_b32 v104, v106
    v_permlane32_swap_b32 v105, v107
    v_pk_add_f32 v[104:105], v[104:105], v[106:107]
    v_min_u32 v104, -2, v104
    v_min_u32 v105, -2, v105
    s_cmp_lt_u32 s28, 4
    v_permlane32_swap_b32 v104, v106
    v_permlane32_swap_b32 v105, v107
    buffer_store_dwordx4 v[104:107], v5, s[60:63], 0 offen sc1
    s_cbranch_scc0 L_fin2
    s_and_b32 s12, s2, 7
    s_lshl_b32 s12, s12, 2
    s_add_u32 s12, s12, s28
    s_lshr_b32 s8, s31, 7
    s_lshl_b32 s8, s8, 16
    s_lshr_b32 s9, s12, 1
    s_lshl_b32 s9, s9, 12
    s_add_u32 s13, s8, s9
    s_and_b32 s9, s12, 1
    s_lshl_b32 s9, s9, 7
    s_add_u32 s13, s13, s9
    s_add_u32 s13, s13, 524800
    v_and_b32 v9, 31, v1
    v_lshlrev_b32 v10, 2, v9
    s_andn2_b32 s8, s27, 0x7ff
    s_xor_b32 s9, s8, 0x80000000
    s_not_b32 s10, s8
    s_bitcmp1_b32 s8, 31
    s_cselect_b32 s8, s9, s10
    v_mov_b32 v116, 0xbfb8aa3b
    v_mul_f32 v116, s8, v116
    v_exp_f32 v116, v116
    v_lshlrev_b32 v8, 4, v0
    v_add_f32 v116, 1.0, v116
    v_rcp_f32 v116, v116
    s_mul_i32 s8, s12, 28672
    s_add_u32 s8, s8, 2097152
    s_add_u32 s9, s8, 8192
    s_add_u32 s10, s8, 16384
    s_add_u32 s11, s8, 24576
    s_cmp_eq_u32 s5, 0
    s_cselect_b32 s11, s11, 0x40000000
    v_and_b32 v11, 7, v1
    v_lshlrev_b32 v11, 7, v11
    v_lshl_add_u32 v11, v240, 2, v11
    v_add_u32 v11, v11, v84
    v_lshlrev_b32 v12, 5, v9
    v_lshlrev_b32 v13, 1, v9
    s_lshl_b32 s14, s31, 11
    s_lshl_b32 s15, s12, 6
    s_add_u32 s14, s14, s15
    buffer_load_dword v117, v10, s[60:63], s13 offen sc1
L_bs:
    s_waitcnt vmcnt(0)
    v_cmp_eq_u32 vcc, -1, v117
    s_nop 0
    s_cbranch_vccz L_bs_ok
    buffer_load_dword v117, v10, s[60:63], s13 offen sc1
    s_add_u32 s26, s26, 1
    s_cmp_lt_u32 s26, 200000
    s_cbranch_scc1 L_bs
    s_waitcnt vmcnt(0)
L_bs_ok:
    buffer_load_dwordx4 v[64:67], v8, s[60:63], s8 offen sc1
    buffer_load_dwordx4 v[68:71], v8, s[60:63], s9 offen sc1
    buffer_load_dwordx4 v[72:75], v8, s[60:63], s10 offen sc1
    buffer_load_dwordx4 v[76:79], v8, s[60:63], s11 offen sc1
L_yp:
    s_waitcnt vmcnt(0)
    v_max_u32 v14, v64, v65
    v_max3_u32 v14, v66, v67, v14
    v_max3_u32 v14, v68, v69, v14
    v_max3_u32 v14, v70, v71, v14
    v_max3_u32 v14, v72, v73, v14
    v_max3_u32 v14, v74, v75, v14
    v_max3_u32 v14, v76, v77, v14
    v_max3_u32 v14, v78, v79, v14
    v_cmp_eq_u32 vcc, -1, v14
    s_nop 0
    s_cbranch_vccz L_yp_ok
    buffer_load_dwordx4 v[64:67], v8, s[60:63], s8 offen sc1
    buffer_load_dwordx4 v[68:71], v8, s[60:63], s9 offen sc1
    buffer_load_dwordx4 v[72:75], v8, s[60:63], s10 offen sc1
    buffer_load_dwordx4 v[76:79], v8, s[60:63], s11 offen sc1
    s_add_u32 s26, s26, 1
    s_cmp_lt_u32 s26, 200000
    s_cbranch_scc1 L_yp
    s_waitcnt vmcnt(0)
L_yp_ok:
    v_pk_add_f32 v[64:65], v[64:65], v[68:69]
    v_pk_add_f32 v[72:73], v[72:73], v[76:77]
    v_pk_add_f32 v[66:67], v[66:67], v[70:71]
    v_pk_add_f32 v[74:75], v[74:75], v[78:79]
    v_pk_add_f32 v[64:65], v[64:65], v[72:73]
    v_pk_add_f32 v[66:67], v[66:67], v[74:75]
    s_nop 1
    v_permlane32_swap_b32 v64, v66
    v_permlane32_swap_b32 v65, v67
    v_pk_add_f32 v[64:65], v[64:65], v[66:67]
    s_nop 1
    v_permlane16_swap_b32 v64, v65
    v_add_f32 v64, v64, v65
    s_nop 1
    v_add_f32_dpp v64, v64, v64 row_ror:8 row_mask:0xf bank_mask:0xf
    s_mov_b32 exec_lo, 0x00ff00ff
    s_mov_b32 exec_hi, 0x00ff00ff
    ds_write_b32 v11, v64 offset:33792
    s_mov_b64 exec, -1
    s_cmp_eq_u32 s3, 0
    s_waitcnt lgkmcnt(0)
    s_barrier
    s_cbranch_scc0 L_fin2
    ds_read_b128 v[64:67], v12 offset:33792
    ds_read_b128 v[68:71], v12 offset:33808
    s_mov_b64 exec, 0xffffffff
    s_waitcnt lgkmcnt(0)
    v_pk_add_f32 v[64:65], v[64:65], v[66:67]
    v_pk_add_f32 v[68:69], v[68:69], v[70:71]
    v_pk_add_f32 v[64:65], v[64:65], v[68:69]
    v_add_f32 v64, v64, v65
    v_fma_f32 v64, v64, v116, v117
    v_cvt_pk_bf16_f32 v64, v64, v64
    buffer_store_short v64, v13, s[64:67], s14 offen
L_fin2:
    s_endpgm
L_slow:
    s_waitcnt vmcnt(0)
    v_and_b32 v32, 15, v1
    v_cmp_eq_u32 vcc, 0, v32
    v_mov_b32 v33, 0x3f803f80
    s_nop 0
    v_cndmask_b32 v250, 0, v33, vcc
    v_cndmask_b32 v251, 0, v33, vcc
    v_cmp_eq_u32 vcc, 4, v32
    s_nop 1
    v_cndmask_b32 v252, 0, v33, vcc
    v_cndmask_b32 v253, 0, v33, vcc
    v_mov_b32 v32, 0xff800000
    s_mov_b32 s12, 0
L_slow1:
    buffer_load_dwordx4 v[140:143], v4, s[60:63], s12 offen sc1
    buffer_load_dwordx4 v[144:147], v4, s[60:63], s12 offen offset:1024 sc1
    s_add_u32 s12, s12, 4096
    s_waitcnt vmcnt(0)
    v_mfma_f32_32x32x16_bf16 v[16:31], v[140:143], v[132:135], 0
    v_mfma_f32_32x32x16_bf16 v[16:31], v[144:147], v[136:139], v[16:31]
    s_nop 11
    v_max3_f32 v32, v16, v17, v32
    v_max3_f32 v32, v18, v19, v32
    v_max3_f32 v32, v20, v21, v32
    v_max3_f32 v32, v22, v23, v32
    v_max3_f32 v32, v24, v25, v32
    v_max3_f32 v32, v26, v27, v32
    v_max3_f32 v32, v28, v29, v32
    v_max3_f32 v32, v30, v31, v32
    s_cmp_lt_u32 s12, 262144
    s_cbranch_scc1 L_slow1
    v_mov_b32 v33, v32
    s_nop 1
    v_permlane32_swap_b32 v32, v33
    v_max_f32 v32, v32, v33
    v_sub_f32 v32, 0, v32
    v_mov_b32 v33, v32
    v_mov_b32 v34, v32
    v_mov_b32 v35, v32
    v_mov_b32 v36, v32
    v_mov_b32 v37, v32
    v_mov_b32 v38, v32
    v_mov_b32 v39, v32
    v_mov_b32 v40, v32
    v_mov_b32 v41, v32
    v_mov_b32 v42, v32
    v_mov_b32 v43, v32
    v_mov_b32 v44, v32
    v_mov_b32 v45, v32
    v_mov_b32 v46, v32
    v_mov_b32 v47, v32
    v_mov_b32 v96, 0
    v_mov_b32 v97, 0
    v_mov_b32 v98, 0
    v_mov_b32 v99, 0
    v_mov_b32 v100, 0
    v_mov_b32 v101, 0
    v_mov_b32 v102, 0
    v_mov_b32 v103, 0
    v_mov_b32 v104, 0
    v_mov_b32 v105, 0
    v_mov_b32 v106, 0
    v_mov_b32 v107, 0
    v_mov_b32 v108, 0
    v_mov_b32 v109, 0
    v_mov_b32 v110, 0
    v_mov_b32 v111, 0
    v_mov_b32 v116, 0
    v_mov_b32 v117, 0
    v_mov_b32 v118, 0
    v_mov_b32 v119, 0
    s_mov_b32 s12, 0
L_slow2:
    s_or_b32 s13, s12, 0x4000
    s_add_u32 s13, s13, 4096
    s_and_b32 s13, s13, 0x3b000
    s_and_b32 s14, s12, 0x4000
    s_or_b32 s13, s13, s14
    buffer_load_dwordx4 v[140:143], v4, s[60:63], s12 offen sc1
    buffer_load_dwordx4 v[144:147], v4, s[60:63], s12 offen offset:1024 sc1
    buffer_load_dwordx4 v[156:159], v4, s[60:63], s13 offen offset:2048 sc1
    buffer_load_dwordx4 v[160:163], v4, s[60:63], s13 offen offset:3072 sc1
    s_add_u32 s12, s12, 4096
    s_waitcnt vmcnt(0)
    v_mfma_f32_32x32x16_bf16 v[16:31], v[140:143], v[132:135], v[32:47]
    v_mfma_f32_32x32x16_bf16 v[16:31], v[144:147], v[136:139], v[16:31]
    s_nop 11
    v_exp_f32 v48, v16
    v_exp_f32 v49, v17
    v_exp_f32 v50, v18
    v_exp_f32 v51, v19
    v_exp_f32 v52, v20
    v_exp_f32 v53, v21
    v_exp_f32 v54, v22
    v_exp_f32 v55, v23
    v_exp_f32 v56, v24
    v_exp_f32 v57, v25
    v_exp_f32 v58, v26
    v_exp_f32 v59, v27
    v_exp_f32 v60, v28
    v_exp_f32 v61, v29
    v_exp_f32 v62, v30
    v_exp_f32 v63, v31
    v_smfmac_f32_32x32x32_bf16 v[96:111], v[156:159], v[48:55], v2
    v_smfmac_f32_16x16x64_bf16 v[116:119], v[250:253], v[48:55], v2
    v_smfmac_f32_32x32x32_bf16 v[96:111], v[160:163], v[56:63], v2
    v_smfmac_f32_16x16x64_bf16 v[116:119], v[250:253], v[56:63], v2
    s_cmp_lt_u32 s12, 262144
    s_cbranch_scc1 L_slow2
    s_nop 15
    v_mov_b32 v117, v116
    s_nop 1
    v_permlane32_swap_b32 v116, v117
    v_rcp_f32 v117, v116
    s_nop 0
    v_pk_mul_f32 v[80:81], v[96:97], v[116:117] op_sel:[0,1] op_sel_hi:[1,1]
    v_pk_mul_f32 v[82:83], v[98:99], v[116:117] op_sel:[0,1] op_sel_hi:[1,1]
    v_pk_mul_f32 v[84:85], v[100:101], v[116:117] op_sel:[0,1] op_sel_hi:[1,1]
    v_pk_mul_f32 v[86:87], v[102:103], v[116:117] op_sel:[0,1] op_sel_hi:[1,1]
    v_cvt_pk_bf16_f32 v48, v80, v81
    v_cvt_pk_bf16_f32 v49, v82, v83
    v_cvt_pk_bf16_f32 v50, v84, v85
    v_cvt_pk_bf16_f32 v51, v86, v87
    buffer_store_dwordx4 v[48:51], v4, s[60:63], s11 offen offset:0 sc1
    v_pk_mul_f32 v[88:89], v[104:105], v[116:117] op_sel:[0,1] op_sel_hi:[1,1]
    v_pk_mul_f32 v[90:91], v[106:107], v[116:117] op_sel:[0,1] op_sel_hi:[1,1]
    v_pk_mul_f32 v[92:93], v[108:109], v[116:117] op_sel:[0,1] op_sel_hi:[1,1]
    v_pk_mul_f32 v[94:95], v[110:111], v[116:117] op_sel:[0,1] op_sel_hi:[1,1]
    v_cvt_pk_bf16_f32 v52, v88, v89
    v_cvt_pk_bf16_f32 v53, v90, v91
    v_cvt_pk_bf16_f32 v54, v92, v93
    v_cvt_pk_bf16_f32 v55, v94, v95
    buffer_store_dwordx4 v[52:55], v4, s[60:63], s11 offen offset:1024 sc1
    s_branch L_slow_ret
L_fin:
L_end:
    s_endpgm
.section .rodata,"a"
.p2align 6
.amdhsa_kernel sequential_preLN__grouped_kv_mqa__moe_arch_mod__prompt_kernel
  .amdhsa_next_free_vgpr 256
  .amdhsa_next_free_sgpr 102
  .amdhsa_accum_offset 256
  .amdhsa_group_segment_fixed_size 0
  .amdhsa_kernarg_size 104
  .amdhsa_user_sgpr_count 2
  .amdhsa_user_sgpr_kernarg_segment_ptr 1
  .amdhsa_system_sgpr_workgroup_id_x 1
.end_amdhsa_kernel
```
